```python
import torch

def _softmax(x, axis=-1):
    return torch.softmax(x, dim=axis)
def _gelu(x):
    return torch.nn.functional.gelu(x, approximate="tanh")
def _silu(x):
    return torch.nn.functional.silu(x)
def _sigmoid(x):
    return torch.sigmoid(x)
def _layernorm(x, axis=-1, eps=1e-5):
    m = x.mean(dim=axis, keepdim=True)
    v = x.var(dim=axis, keepdim=True, unbiased=False)
    return (x - m) / torch.sqrt(v + eps)
def _scatter_add(tgt, idx, src, axis=0):
    return tgt.clone().index_add_(axis, idx, src)
def _segment_sum(src, seg, n):
    out = torch.zeros((n,) + src.shape[1:], dtype=src.dtype)
    return out.index_add_(0, seg, src)
def _pad(x, pw):
    flat = tuple(v for pair in reversed(pw) for v in pair)
    return torch.nn.functional.pad(x, flat)

kernel_name = 'standalone__dense_activation_relu__prompt'

def setup_inputs():

    _w = (lambda a: (lambda t: t.to(torch.bfloat16) if t.is_floating_point() else t)(torch.as_tensor(a)))
    B, S, D, Dff = 1, 2048, 512, 1792
    return {
        "x": _w((lambda *s: torch.randn(*s, dtype=torch.bfloat16) * 0.05)(B, S, D)),
        "w1": _w((lambda *s: torch.randn(*s, dtype=torch.bfloat16) * 0.05)(D, Dff)),
        "w2": _w((lambda *s: torch.randn(*s, dtype=torch.bfloat16) * 0.05)(Dff, D)),
    }

def reference(x, w1, w2):
    h = torch.einsum("bsd,df->bsf", x, w1)
    zero = torch.zeros_like(h)
    h = torch.maximum(h, zero)
    return torch.einsum("bsf,fd->bsd", h, w2)
```

```asm
; @launch grid=(256,1,1) block=(256,1,1) lds=163840
.amdgcn_target "amdgcn-amd-amdhsa--gfx950"
.text
.globl standalone__dense_activation_relu__prompt_kernel
.p2align 8
.type standalone__dense_activation_relu__prompt_kernel,@function
standalone__dense_activation_relu__prompt_kernel:
    s_cmp_ge_u32 s2, 256
    s_cbranch_scc1 L_end
    s_load_dwordx2 s[40:41], s[0:1], 0
    s_load_dwordx2 s[44:45], s[0:1], 8
    s_load_dwordx4 s[8:11], s[0:1], 16
    s_load_dwordx2 s[14:15], s[0:1], 40
    s_cmp_lt_u32 s2, 224
    v_lshrrev_b32 v164, 6, v0
    s_cbranch_scc1 L_nocpf
    s_getpc_b64 s[64:65]
L_pc:
    s_mov_b32 s66, L_end-L_pc
    s_mov_b32 s67, 0x20000
    v_lshlrev_b32 v15, 7, v0
    buffer_load_dword v15, v15, s[64:67], 0 offen
L_nocpf:
    v_readfirstlane_b32 s16, v164
    v_and_b32 v1, 63, v0
    s_and_b32 s17, s2, 7
    s_lshr_b32 s18, s2, 3
    s_lshl_b32 s17, s17, 2
    s_lshr_b32 s17, 0x75643120, s17
    s_and_b32 s17, s17, 7
    s_mul_i32 s23, s18, 37
    s_lshr_b32 s23, s23, 8
    s_mul_i32 s21, s23, 7
    s_sub_u32 s21, s18, s21
    s_add_u32 s26, s21, s23
    s_and_b32 s26, s26, 1
    s_lshl_b32 s26, s26, 9
    s_and_b32 s19, s17, 6
    s_lshl_b32 s19, s19, 1
    s_add_u32 s19, s19, s23
    s_and_b32 s20, s17, 1
    s_mul_i32 s20, s20, 7
    s_add_u32 s20, s20, s21
    s_lshl_b32 s21, s19, 17
    v_lshl_add_u32 v164, v164, 15, s21
    v_lshrrev_b32 v165, 3, v1
    v_lshl_add_u32 v164, v165, 10, v164
    v_lshrrev_b32 v165, 4, v1
    v_and_b32 v166, 7, v1
    v_xor_b32 v166, v166, v165
    v_lshl_add_u32 v144, v166, 4, v164
    v_xor_b32 v145, 64, v144
    v_add_u32 v145, 7168, v145
    v_add_u32 v146, 14336, v144
    v_add_u32 v147, 14336, v145
    s_mul_i32 s31, s16, 6144
    s_mov_b32 s42, 2097152
    s_mov_b32 s43, 0x20000
    s_mov_b32 m0, s31
    s_cmp_ge_u32 s18, 28
    s_waitcnt lgkmcnt(0)
    s_cbranch_scc1 L_idle
    buffer_load_dwordx4 v144, s[40:43], s26 offen offset:0 lds
    s_mul_i32 s27, s26, 1792
    buffer_load_dwordx4 v145, s[40:43], s26 offen offset:1024 lds
    buffer_load_dwordx4 v146, s[40:43], s26 offen offset:2048 lds
    buffer_load_dwordx4 v147, s[40:43], s26 offen offset:3072 lds
    s_add_u32 s26, s26, 128
    s_and_b32 s26, s26, 0x3ff
    s_lshl_b32 s22, s20, 8
    s_mul_i32 s21, s16, 57344
    s_add_u32 s21, s21, s22
    v_lshrrev_b32 v164, 3, v1
    v_mul_u32_u24 v164, 3584, v164
    v_and_b32 v165, 1, v165
    v_lshlrev_b32 v165, 2, v165
    v_and_b32 v167, 7, v1
    v_xor_b32 v165, v165, v167
    v_lshl_add_u32 v164, v165, 4, v164
    v_add_u32 v148, s21, v164
    v_add_u32 v149, 27648, v148
    s_mov_b32 s46, 1835008
    s_mov_b32 s47, 0x20000
    s_lshl_b32 s28, s16, 13
    s_add_u32 m0, s31, 4096
    s_nop 0
    buffer_load_dwordx4 v148, s[44:47], s27 offen offset:0 lds
    buffer_load_dwordx4 v149, s[44:47], s27 offen offset:1024 lds
    v_and_b32 v164, 31, v1
    v_lshl_add_u32 v164, v164, 7, s31
    v_bfe_u32 v165, v1, 1, 3
    v_lshrrev_b32 v166, 5, v1
    v_xor_b32 v165, v165, v166
    v_lshl_add_u32 v150, v165, 4, v164
    v_xor_b32 v151, 32, v150
    v_xor_b32 v152, 64, v150
    v_xor_b32 v153, 96, v150
    v_bfe_u32 v165, v1, 2, 2
    v_lshl_add_u32 v164, v166, 3, v165
    v_lshlrev_b32 v164, 7, v164
    v_bfe_u32 v165, v1, 3, 1
    v_lshl_add_u32 v164, v165, 6, v164
    v_bfe_u32 v166, v1, 4, 1
    v_lshl_add_u32 v164, v166, 5, v164
    v_and_b32 v166, 3, v1
    v_lshl_add_u32 v158, v166, 3, v164
    v_xor_b32 v159, 64, v158
    v_add_u32 v154, 49152, v150
    v_add_u32 v155, 49152, v151
    v_add_u32 v156, 49152, v152
    v_add_u32 v157, 49152, v153
    v_add_u32 v160, 49152, v158
    v_add_u32 v162, 98304, v158
    v_add_u32 v161, 49152, v159
    v_add_u32 v163, 98304, v159
    s_add_u32 m0, s31, 24576
    s_nop 0
    buffer_load_dwordx4 v144, s[40:43], s26 offen offset:0 lds
    s_mul_i32 s27, s26, 1792
    buffer_load_dwordx4 v145, s[40:43], s26 offen offset:1024 lds
    buffer_load_dwordx4 v146, s[40:43], s26 offen offset:2048 lds
    buffer_load_dwordx4 v147, s[40:43], s26 offen offset:3072 lds
    s_add_u32 s26, s26, 128
    s_and_b32 s26, s26, 0x3ff
    s_add_u32 m0, s31, 28672
    s_nop 0
    buffer_load_dwordx4 v148, s[44:47], s27 offen offset:0 lds
    buffer_load_dwordx4 v149, s[44:47], s27 offen offset:1024 lds
    s_add_u32 m0, s31, 49152
    s_nop 0
    buffer_load_dwordx4 v144, s[40:43], s26 offen offset:0 lds
    s_mul_i32 s27, s26, 1792
    buffer_load_dwordx4 v145, s[40:43], s26 offen offset:1024 lds
    s_load_dwordx2 s[24:25], s[14:15], 262144
    s_mov_b32 s48, s8
    s_mov_b32 s49, s9
    s_mov_b32 s50, 1835008
    s_mov_b32 s51, 0x20000
    s_mov_b32 s52, s10
    s_mov_b32 s53, s11
    s_mov_b32 s54, 2097152
    s_mov_b32 s55, 0x20000
    s_mov_b32 s60, s14
    s_mov_b32 s61, s15
    s_mov_b32 s62, 262272
    s_mov_b32 s63, 0x20000
    s_add_u32 s56, s14, 1048576
    s_addc_u32 s57, s15, 0
    s_mov_b32 s58, 7340032
    s_mov_b32 s59, 0x20000
    s_mul_i32 s21, s18, 37
    s_lshr_b32 s21, s21, 8
    s_mul_i32 s22, s21, 7
    s_sub_u32 s22, s18, s22
    s_cmp_ge_u32 s22, 3
    s_addc_u32 s32, s22, 0
    s_cmp_ge_u32 s18, 28
    s_cselect_b32 s21, s22, s21
    s_cselect_b32 s32, 3, s32
    s_lshl_b32 s22, s17, 2
    s_add_u32 s36, s21, s22
    s_mov_b32 s29, 0
    s_movk_i32 s90, 0
    s_movk_i32 s91, 4096
    s_movk_i32 s92, 8192
    s_movk_i32 s93, 12288
    s_movk_i32 s94, 16384
    s_movk_i32 s95, 20480
    s_movk_i32 s4, 24576
    s_mul_i32 s21, s16, 458752
    s_lshl_b32 s22, s32, 7
    s_add_u32 s21, s21, s22
    v_lshrrev_b32 v164, 3, v1
    v_lshl_add_u32 v164, v164, 10, s21
    v_lshrrev_b32 v165, 4, v1
    v_lshlrev_b32 v165, 1, v165
    v_and_b32 v166, 7, v1
    v_xor_b32 v166, v166, v165
    v_lshl_add_u32 v4, v166, 4, v164
    v_add_u32 v5, 7168, v4
    v_add_u32 v6, 14336, v4
    v_add_u32 v7, 21504, v4
    v_lshrrev_b32 v164, 5, v1
    v_lshlrev_b32 v164, 4, v164
    v_bfe_u32 v165, v1, 2, 3
    v_add_u32 v164, v164, v165
    v_lshl_add_u32 v164, v164, 7, s28
    v_lshrrev_b32 v165, 1, v165
    v_lshl_add_u32 v164, v165, 5, v164
    v_and_b32 v166, 3, v1
    v_lshl_add_u32 v8, v166, 3, v164
    v_xor_b32 v9, 32, v8
    v_xor_b32 v10, 64, v8
    v_xor_b32 v11, 96, v8
    v_add_u32 v12, 65536, v8
    v_add_u32 v13, 65536, v9
    v_add_u32 v0, 65536, v10
    v_add_u32 v191, 65536, v11
    v_add_u32 v180, 131072, v8
    v_add_u32 v181, 131072, v9
    v_add_u32 v182, 131072, v10
    v_add_u32 v183, 131072, v11
    s_lshr_b32 s21, s36, 1
    s_lshl_b32 s34, s21, 4
    s_mul_i32 s22, s16, 7
    s_lshr_b32 s22, s22, 1
    s_add_u32 s22, s22, s34
    s_lshl_b32 s22, s22, 2
    s_and_b32 s23, s36, 1
    s_lshl_b32 s23, s23, 1
    s_add_u32 s22, s22, s23
    s_lshl_b32 s22, s22, 7
    v_bfe_u32 v164, v1, 1, 2
    v_and_b32 v165, 1, v1
    v_lshl_add_u32 v164, v164, 2, v165
    v_lshl_add_u32 v14, v164, 7, s22
    s_lshl_b32 s35, s19, 4
    s_add_u32 s35, s35, s20
    s_lshl_b32 s35, s35, 2
    s_add_u32 s35, s35, s16
    s_lshl_b32 s35, s35, 7
    s_lshl_b32 s21, s19, 2
    s_add_u32 s21, s21, s16
    s_mul_i32 s21, s21, 112
    s_lshl_b32 s22, s20, 3
    s_add_u32 s21, s21, s22
    s_lshl_b32 s21, s21, 10
    v_and_b32 v164, 15, v1
    v_lshl_add_u32 v164, v164, 4, s21
    v_bfe_u32 v165, v1, 4, 1
    v_lshl_add_u32 v164, v165, 10, v164
    v_lshrrev_b32 v165, 5, v1
    v_lshl_add_u32 v2, v165, 8, v164
    v_and_b32 v164, 15, v1
    v_lshl_add_u32 v164, v164, 8, s28
    v_lshrrev_b32 v165, 4, v1
    v_and_b32 v166, 7, v1
    v_xor_b32 v165, v165, v166
    v_lshl_add_u32 v184, v165, 4, v164
    v_xor_b32 v185, 64, v184
    s_lshl_b32 s21, s16, 11
    v_lshrrev_b32 v164, 3, v1
    v_lshlrev_b32 v165, 1, v166
    v_xor_b32 v165, v165, v164
    v_lshl_add_u32 v188, v164, 8, s21
    v_lshl_add_u32 v188, v165, 4, v188
    v_xor_b32 v189, 16, v188
    s_lshl_b32 s21, s36, 16
    s_lshl_b32 s22, s16, 13
    s_add_u32 s21, s21, s22
    s_lshl_b32 s22, s32, 7
    s_add_u32 s21, s21, s22
    v_lshl_add_u32 v164, v164, 10, s21
    v_lshl_add_u32 v190, v166, 4, v164
    s_mul_i32 s21, s36, 224
    s_mul_i32 s22, s16, 28
    s_add_u32 s21, s21, s22
    s_lshl_b32 s37, s21, 10
    s_mov_b32 s68, 114688
    s_mov_b32 s69, 0
    s_mov_b32 s38, 32768
    s_lshl_b32 s12, s16, 11
    s_mov_b32 s13, 4096
    s_waitcnt vmcnt(8)
    s_waitcnt lgkmcnt(0)
    s_barrier
    ds_read_b128 v[16:19], v150 offset:0
    ds_read_b64_tr_b16 a[224:225], v158 offset:4096
    ds_read_b64_tr_b16 a[226:227], v158 offset:4608
    ds_read_b64_tr_b16 a[228:229], v159 offset:4096
    ds_read_b64_tr_b16 a[230:231], v159 offset:4608
    ds_read_b128 v[20:23], v151 offset:0
    ds_read_b64_tr_b16 a[232:233], v158 offset:10240
    ds_read_b64_tr_b16 a[234:235], v158 offset:10752
    ds_read_b64_tr_b16 a[236:237], v159 offset:10240
    ds_read_b64_tr_b16 a[238:239], v159 offset:10752
    ds_read_b128 v[24:27], v152 offset:0
    ds_read_b64_tr_b16 a[240:241], v158 offset:16384
    ds_read_b64_tr_b16 a[242:243], v158 offset:16896
    s_waitcnt lgkmcnt(10)
    v_mfma_f32_32x32x16_bf16 v[192:207], a[224:227], v[16:19], 0
    buffer_load_dwordx4 v146, s[40:43], s26 offen offset:2048 lds
    ds_read_b64_tr_b16 a[244:245], v159 offset:16384
    ds_read_b64_tr_b16 a[246:247], v159 offset:16896
    s_waitcnt lgkmcnt(10)
    v_mfma_f32_32x32x16_bf16 v[208:223], a[228:231], v[16:19], 0
    buffer_load_dwordx4 v147, s[40:43], s26 offen offset:3072 lds
    s_add_u32 s26, s26, 128
    s_and_b32 s26, s26, 0x3ff
    ds_read_b128 v[28:31], v153 offset:0
    ds_read_b64_tr_b16 a[248:249], v158 offset:22528
    ds_read_b64_tr_b16 a[250:251], v158 offset:23040
    s_waitcnt lgkmcnt(10)
    v_mfma_f32_32x32x16_bf16 v[192:207], a[232:235], v[20:23], v[192:207]
    s_add_u32 m0, s31, 53248
    s_nop 0
    buffer_load_dwordx4 v148, s[44:47], s27 offen offset:0 lds
    ds_read_b64_tr_b16 a[252:253], v159 offset:22528
    ds_read_b64_tr_b16 a[254:255], v159 offset:23040
    s_waitcnt lgkmcnt(10)
    v_mfma_f32_32x32x16_bf16 v[208:223], a[236:239], v[20:23], v[208:223]
    buffer_load_dwordx4 v149, s[44:47], s27 offen offset:1024 lds
    s_waitcnt lgkmcnt(7)
    v_mfma_f32_32x32x16_bf16 v[192:207], a[240:243], v[24:27], v[192:207]
    s_waitcnt lgkmcnt(5)
    v_mfma_f32_32x32x16_bf16 v[208:223], a[244:247], v[24:27], v[208:223]
    s_waitcnt vmcnt(6)
    s_barrier
    s_add_u32 m0, s31, 73728
    s_nop 0
    buffer_load_dwordx4 v144, s[40:43], s26 offen offset:0 lds
    s_mul_i32 s27, s26, 1792
    ds_read_b128 v[32:35], v150 offset:24576
    ds_read_b64_tr_b16 a[224:225], v158 offset:28672
    ds_read_b64_tr_b16 a[226:227], v158 offset:29184
    ds_read_b64_tr_b16 a[228:229], v159 offset:28672
    ds_read_b64_tr_b16 a[230:231], v159 offset:29184
    ds_read_b128 v[36:39], v151 offset:24576
    ds_read_b64_tr_b16 a[232:233], v158 offset:34816
    ds_read_b64_tr_b16 a[234:235], v158 offset:35328
    s_waitcnt lgkmcnt(10)
    v_mfma_f32_32x32x16_bf16 v[192:207], a[248:251], v[28:31], v[192:207]
    buffer_load_dwordx4 v145, s[40:43], s26 offen offset:1024 lds
    ds_read_b64_tr_b16 a[236:237], v159 offset:34816
    ds_read_b64_tr_b16 a[238:239], v159 offset:35328
    s_waitcnt lgkmcnt(10)
    v_mfma_f32_32x32x16_bf16 v[208:223], a[252:255], v[28:31], v[208:223]
    buffer_load_dwordx4 v146, s[40:43], s26 offen offset:2048 lds
    ds_read_b128 v[40:43], v152 offset:24576
    ds_read_b64_tr_b16 a[240:241], v158 offset:40960
    ds_read_b64_tr_b16 a[242:243], v158 offset:41472
    s_waitcnt lgkmcnt(10)
    v_mfma_f32_32x32x16_bf16 v[192:207], a[224:227], v[32:35], v[192:207]
    buffer_load_dwordx4 v147, s[40:43], s26 offen offset:3072 lds
    s_add_u32 s26, s26, 128
    s_and_b32 s26, s26, 0x3ff
    ds_read_b64_tr_b16 a[244:245], v159 offset:40960
    ds_read_b64_tr_b16 a[246:247], v159 offset:41472
    s_waitcnt lgkmcnt(10)
    v_mfma_f32_32x32x16_bf16 v[208:223], a[228:231], v[32:35], v[208:223]
    s_add_u32 m0, s31, 77824
    s_nop 0
    buffer_load_dwordx4 v148, s[44:47], s27 offen offset:0 lds
    ds_read_b128 v[44:47], v153 offset:24576
    ds_read_b64_tr_b16 a[248:249], v158 offset:47104
    ds_read_b64_tr_b16 a[250:251], v158 offset:47616
    s_waitcnt lgkmcnt(10)
    v_mfma_f32_32x32x16_bf16 v[192:207], a[232:235], v[36:39], v[192:207]
    buffer_load_dwordx4 v149, s[44:47], s27 offen offset:1024 lds
    ds_read_b64_tr_b16 a[252:253], v159 offset:47104
    ds_read_b64_tr_b16 a[254:255], v159 offset:47616
    s_waitcnt lgkmcnt(10)
    v_mfma_f32_32x32x16_bf16 v[208:223], a[236:239], v[36:39], v[208:223]
    s_waitcnt lgkmcnt(7)
    v_mfma_f32_32x32x16_bf16 v[192:207], a[240:243], v[40:43], v[192:207]
    s_waitcnt lgkmcnt(5)
    v_mfma_f32_32x32x16_bf16 v[208:223], a[244:247], v[40:43], v[208:223]
    s_waitcnt vmcnt(6)
    s_barrier
    s_add_u32 m0, s31, 0
    s_nop 0
    buffer_load_dwordx4 v144, s[40:43], s26 offen offset:0 lds
    s_mul_i32 s27, s26, 1792
    ds_read_b128 v[48:51], v154 offset:0
    ds_read_b64_tr_b16 a[224:225], v160 offset:4096
    ds_read_b64_tr_b16 a[226:227], v160 offset:4608
    ds_read_b64_tr_b16 a[228:229], v161 offset:4096
    ds_read_b64_tr_b16 a[230:231], v161 offset:4608
    ds_read_b128 v[52:55], v155 offset:0
    ds_read_b64_tr_b16 a[232:233], v160 offset:10240
    ds_read_b64_tr_b16 a[234:235], v160 offset:10752
    s_waitcnt lgkmcnt(10)
    v_mfma_f32_32x32x16_bf16 v[192:207], a[248:251], v[44:47], v[192:207]
    buffer_load_dwordx4 v145, s[40:43], s26 offen offset:1024 lds
    ds_read_b64_tr_b16 a[236:237], v161 offset:10240
    ds_read_b64_tr_b16 a[238:239], v161 offset:10752
    s_waitcnt lgkmcnt(10)
    v_mfma_f32_32x32x16_bf16 v[208:223], a[252:255], v[44:47], v[208:223]
    buffer_load_dwordx4 v146, s[40:43], s26 offen offset:2048 lds
    ds_read_b128 v[56:59], v156 offset:0
    ds_read_b64_tr_b16 a[240:241], v160 offset:16384
    ds_read_b64_tr_b16 a[242:243], v160 offset:16896
    s_waitcnt lgkmcnt(10)
    v_mfma_f32_32x32x16_bf16 v[192:207], a[224:227], v[48:51], v[192:207]
    buffer_load_dwordx4 v147, s[40:43], s26 offen offset:3072 lds
    s_add_u32 s26, s26, 128
    s_and_b32 s26, s26, 0x3ff
    ds_read_b64_tr_b16 a[244:245], v161 offset:16384
    ds_read_b64_tr_b16 a[246:247], v161 offset:16896
    s_waitcnt lgkmcnt(10)
    v_mfma_f32_32x32x16_bf16 v[208:223], a[228:231], v[48:51], v[208:223]
    s_add_u32 m0, s31, 4096
    s_nop 0
    buffer_load_dwordx4 v148, s[44:47], s27 offen offset:0 lds
    ds_read_b128 v[60:63], v157 offset:0
    ds_read_b64_tr_b16 a[248:249], v160 offset:22528
    ds_read_b64_tr_b16 a[250:251], v160 offset:23040
    s_waitcnt lgkmcnt(10)
    v_mfma_f32_32x32x16_bf16 v[192:207], a[232:235], v[52:55], v[192:207]
    buffer_load_dwordx4 v149, s[44:47], s27 offen offset:1024 lds
    ds_read_b64_tr_b16 a[252:253], v161 offset:22528
    ds_read_b64_tr_b16 a[254:255], v161 offset:23040
    s_waitcnt lgkmcnt(10)
    v_mfma_f32_32x32x16_bf16 v[208:223], a[236:239], v[52:55], v[208:223]
    s_waitcnt lgkmcnt(7)
    v_mfma_f32_32x32x16_bf16 v[192:207], a[240:243], v[56:59], v[192:207]
    s_waitcnt lgkmcnt(5)
    v_mfma_f32_32x32x16_bf16 v[208:223], a[244:247], v[56:59], v[208:223]
    s_waitcnt vmcnt(6)
    s_barrier
    s_add_u32 m0, s31, 24576
    s_nop 0
    buffer_load_dwordx4 v144, s[40:43], s26 offen offset:0 lds
    s_mul_i32 s27, s26, 1792
    ds_read_b128 v[64:67], v154 offset:24576
    ds_read_b64_tr_b16 a[224:225], v160 offset:28672
    ds_read_b64_tr_b16 a[226:227], v160 offset:29184
    ds_read_b64_tr_b16 a[228:229], v161 offset:28672
    ds_read_b64_tr_b16 a[230:231], v161 offset:29184
    ds_read_b128 v[68:71], v155 offset:24576
    ds_read_b64_tr_b16 a[232:233], v160 offset:34816
    ds_read_b64_tr_b16 a[234:235], v160 offset:35328
    s_waitcnt lgkmcnt(10)
    v_mfma_f32_32x32x16_bf16 v[192:207], a[248:251], v[60:63], v[192:207]
    buffer_load_dwordx4 v145, s[40:43], s26 offen offset:1024 lds
    ds_read_b64_tr_b16 a[236:237], v161 offset:34816
    ds_read_b64_tr_b16 a[238:239], v161 offset:35328
    s_waitcnt lgkmcnt(10)
    v_mfma_f32_32x32x16_bf16 v[208:223], a[252:255], v[60:63], v[208:223]
    buffer_load_dwordx4 v146, s[40:43], s26 offen offset:2048 lds
    ds_read_b128 v[72:75], v156 offset:24576
    ds_read_b64_tr_b16 a[240:241], v160 offset:40960
    ds_read_b64_tr_b16 a[242:243], v160 offset:41472
    s_waitcnt lgkmcnt(10)
    v_mfma_f32_32x32x16_bf16 v[192:207], a[224:227], v[64:67], v[192:207]
    buffer_load_dwordx4 v147, s[40:43], s26 offen offset:3072 lds
    s_add_u32 s26, s26, 128
    s_and_b32 s26, s26, 0x3ff
    ds_read_b64_tr_b16 a[244:245], v161 offset:40960
    ds_read_b64_tr_b16 a[246:247], v161 offset:41472
    s_waitcnt lgkmcnt(10)
    v_mfma_f32_32x32x16_bf16 v[208:223], a[228:231], v[64:67], v[208:223]
    s_add_u32 m0, s31, 28672
    s_nop 0
    buffer_load_dwordx4 v148, s[44:47], s27 offen offset:0 lds
    ds_read_b128 v[76:79], v157 offset:24576
    ds_read_b64_tr_b16 a[248:249], v160 offset:47104
    ds_read_b64_tr_b16 a[250:251], v160 offset:47616
    s_waitcnt lgkmcnt(10)
    v_mfma_f32_32x32x16_bf16 v[192:207], a[232:235], v[68:71], v[192:207]
    buffer_load_dwordx4 v149, s[44:47], s27 offen offset:1024 lds
    ds_read_b64_tr_b16 a[252:253], v161 offset:47104
    ds_read_b64_tr_b16 a[254:255], v161 offset:47616
    s_waitcnt lgkmcnt(10)
    v_mfma_f32_32x32x16_bf16 v[208:223], a[236:239], v[68:71], v[208:223]
    s_waitcnt lgkmcnt(7)
    v_mfma_f32_32x32x16_bf16 v[192:207], a[240:243], v[72:75], v[192:207]
    s_waitcnt lgkmcnt(5)
    v_mfma_f32_32x32x16_bf16 v[208:223], a[244:247], v[72:75], v[208:223]
    s_waitcnt vmcnt(6)
    s_barrier
    s_add_u32 m0, s31, 49152
    s_nop 0
    buffer_load_dwordx4 v144, s[40:43], s26 offen offset:0 lds
    s_mul_i32 s27, s26, 1792
    ds_read_b128 v[80:83], v150 offset:0
    ds_read_b64_tr_b16 a[224:225], v158 offset:4096
    ds_read_b64_tr_b16 a[226:227], v158 offset:4608
    ds_read_b64_tr_b16 a[228:229], v159 offset:4096
    ds_read_b64_tr_b16 a[230:231], v159 offset:4608
    ds_read_b128 v[84:87], v151 offset:0
    ds_read_b64_tr_b16 a[232:233], v158 offset:10240
    ds_read_b64_tr_b16 a[234:235], v158 offset:10752
    s_waitcnt lgkmcnt(10)
    v_mfma_f32_32x32x16_bf16 v[192:207], a[248:251], v[76:79], v[192:207]
    buffer_load_dwordx4 v145, s[40:43], s26 offen offset:1024 lds
    ds_read_b64_tr_b16 a[236:237], v159 offset:10240
    ds_read_b64_tr_b16 a[238:239], v159 offset:10752
    s_waitcnt lgkmcnt(10)
    v_mfma_f32_32x32x16_bf16 v[208:223], a[252:255], v[76:79], v[208:223]
    buffer_load_dwordx4 v146, s[40:43], s26 offen offset:2048 lds
    ds_read_b128 v[88:91], v152 offset:0
    ds_read_b64_tr_b16 a[240:241], v158 offset:16384
    ds_read_b64_tr_b16 a[242:243], v158 offset:16896
    s_waitcnt lgkmcnt(10)
    v_mfma_f32_32x32x16_bf16 v[192:207], a[224:227], v[80:83], v[192:207]
    buffer_load_dwordx4 v147, s[40:43], s26 offen offset:3072 lds
    s_add_u32 s26, s26, 128
    s_and_b32 s26, s26, 0x3ff
    ds_read_b64_tr_b16 a[244:245], v159 offset:16384
    ds_read_b64_tr_b16 a[246:247], v159 offset:16896
    s_waitcnt lgkmcnt(10)
    v_mfma_f32_32x32x16_bf16 v[208:223], a[228:231], v[80:83], v[208:223]
    s_add_u32 m0, s31, 53248
    s_nop 0
    buffer_load_dwordx4 v148, s[44:47], s27 offen offset:0 lds
    ds_read_b128 v[92:95], v153 offset:0
    ds_read_b64_tr_b16 a[248:249], v158 offset:22528
    ds_read_b64_tr_b16 a[250:251], v158 offset:23040
    s_waitcnt lgkmcnt(10)
    v_mfma_f32_32x32x16_bf16 v[192:207], a[232:235], v[84:87], v[192:207]
    buffer_load_dwordx4 v149, s[44:47], s27 offen offset:1024 lds
    ds_read_b64_tr_b16 a[252:253], v159 offset:22528
    ds_read_b64_tr_b16 a[254:255], v159 offset:23040
    s_waitcnt lgkmcnt(10)
    v_mfma_f32_32x32x16_bf16 v[208:223], a[236:239], v[84:87], v[208:223]
    s_waitcnt lgkmcnt(7)
    v_mfma_f32_32x32x16_bf16 v[192:207], a[240:243], v[88:91], v[192:207]
    s_waitcnt lgkmcnt(5)
    v_mfma_f32_32x32x16_bf16 v[208:223], a[244:247], v[88:91], v[208:223]
    s_waitcnt vmcnt(6)
    s_barrier
    s_add_u32 m0, s31, 73728
    s_nop 0
    buffer_load_dwordx4 v144, s[40:43], s26 offen offset:0 lds
    s_mul_i32 s27, s26, 1792
    ds_read_b128 v[96:99], v150 offset:24576
    ds_read_b64_tr_b16 a[224:225], v158 offset:28672
    ds_read_b64_tr_b16 a[226:227], v158 offset:29184
    ds_read_b64_tr_b16 a[228:229], v159 offset:28672
    ds_read_b64_tr_b16 a[230:231], v159 offset:29184
    ds_read_b128 v[100:103], v151 offset:24576
    ds_read_b64_tr_b16 a[232:233], v158 offset:34816
    ds_read_b64_tr_b16 a[234:235], v158 offset:35328
    s_waitcnt lgkmcnt(10)
    v_mfma_f32_32x32x16_bf16 v[192:207], a[248:251], v[92:95], v[192:207]
    buffer_load_dwordx4 v145, s[40:43], s26 offen offset:1024 lds
    ds_read_b64_tr_b16 a[236:237], v159 offset:34816
    ds_read_b64_tr_b16 a[238:239], v159 offset:35328
    s_waitcnt lgkmcnt(10)
    v_mfma_f32_32x32x16_bf16 v[208:223], a[252:255], v[92:95], v[208:223]
    buffer_load_dwordx4 v146, s[40:43], s26 offen offset:2048 lds
    ds_read_b128 v[104:107], v152 offset:24576
    ds_read_b64_tr_b16 a[240:241], v158 offset:40960
    ds_read_b64_tr_b16 a[242:243], v158 offset:41472
    s_waitcnt lgkmcnt(10)
    v_mfma_f32_32x32x16_bf16 v[192:207], a[224:227], v[96:99], v[192:207]
    buffer_load_dwordx4 v147, s[40:43], s26 offen offset:3072 lds
    s_add_u32 s26, s26, 128
    s_and_b32 s26, s26, 0x3ff
    ds_read_b64_tr_b16 a[244:245], v159 offset:40960
    ds_read_b64_tr_b16 a[246:247], v159 offset:41472
    s_waitcnt lgkmcnt(10)
    v_mfma_f32_32x32x16_bf16 v[208:223], a[228:231], v[96:99], v[208:223]
    s_add_u32 m0, s31, 77824
    s_nop 0
    buffer_load_dwordx4 v148, s[44:47], s27 offen offset:0 lds
    ds_read_b128 v[108:111], v153 offset:24576
    ds_read_b64_tr_b16 a[248:249], v158 offset:47104
    ds_read_b64_tr_b16 a[250:251], v158 offset:47616
    s_waitcnt lgkmcnt(10)
    v_mfma_f32_32x32x16_bf16 v[192:207], a[232:235], v[100:103], v[192:207]
    buffer_load_dwordx4 v149, s[44:47], s27 offen offset:1024 lds
    ds_read_b64_tr_b16 a[252:253], v159 offset:47104
    ds_read_b64_tr_b16 a[254:255], v159 offset:47616
    s_waitcnt lgkmcnt(10)
    v_mfma_f32_32x32x16_bf16 v[208:223], a[236:239], v[100:103], v[208:223]
    s_mul_i32 s27, s26, 1792
    s_add_u32 m0, s12, 98304
    s_add_u32 s26, s26, 128
    s_and_b32 s26, s26, 0x3ff
    s_add_u32 s27, s27, 128
    buffer_load_dwordx4 v148, s[44:47], s27 offen offset:0 lds
    s_waitcnt lgkmcnt(7)
    v_mfma_f32_32x32x16_bf16 v[192:207], a[240:243], v[104:107], v[192:207]
    buffer_load_dwordx4 v149, s[44:47], s27 offen offset:1024 lds
    s_waitcnt lgkmcnt(5)
    v_mfma_f32_32x32x16_bf16 v[208:223], a[244:247], v[104:107], v[208:223]
    s_waitcnt vmcnt(8)
    s_barrier
    s_mul_i32 s27, s26, 1792
    s_add_u32 m0, s12, 106496
    s_add_u32 s26, s26, 128
    s_and_b32 s26, s26, 0x3ff
    s_add_u32 s27, s27, 128
    buffer_load_dwordx4 v148, s[44:47], s27 offen offset:0 lds
    ds_read_b128 v[112:115], v154 offset:0
    ds_read_b64_tr_b16 a[224:225], v160 offset:4096
    ds_read_b64_tr_b16 a[226:227], v160 offset:4608
    ds_read_b64_tr_b16 a[228:229], v161 offset:4096
    ds_read_b64_tr_b16 a[230:231], v161 offset:4608
    ds_read_b128 v[116:119], v155 offset:0
    ds_read_b64_tr_b16 a[232:233], v160 offset:10240
    ds_read_b64_tr_b16 a[234:235], v160 offset:10752
    s_waitcnt lgkmcnt(10)
    v_mfma_f32_32x32x16_bf16 v[192:207], a[248:251], v[108:111], v[192:207]
    buffer_load_dwordx4 v149, s[44:47], s27 offen offset:1024 lds
    ds_read_b64_tr_b16 a[236:237], v161 offset:10240
    ds_read_b64_tr_b16 a[238:239], v161 offset:10752
    s_waitcnt lgkmcnt(10)
    v_mfma_f32_32x32x16_bf16 v[208:223], a[252:255], v[108:111], v[208:223]
    s_mul_i32 s27, s26, 1792
    s_add_u32 m0, s12, 114688
    s_add_u32 s26, s26, 128
    s_and_b32 s26, s26, 0x3ff
    s_add_u32 s27, s27, 128
    buffer_load_dwordx4 v148, s[44:47], s27 offen offset:0 lds
    ds_read_b128 v[120:123], v156 offset:0
    ds_read_b64_tr_b16 a[240:241], v160 offset:16384
    ds_read_b64_tr_b16 a[242:243], v160 offset:16896
    s_waitcnt lgkmcnt(10)
    v_mfma_f32_32x32x16_bf16 v[192:207], a[224:227], v[112:115], v[192:207]
    buffer_load_dwordx4 v149, s[44:47], s27 offen offset:1024 lds
    ds_read_b64_tr_b16 a[244:245], v161 offset:16384
    ds_read_b64_tr_b16 a[246:247], v161 offset:16896
    s_waitcnt lgkmcnt(10)
    v_mfma_f32_32x32x16_bf16 v[208:223], a[228:231], v[112:115], v[208:223]
    s_mul_i32 s27, s26, 1792
    s_add_u32 m0, s12, 122880
    s_add_u32 s26, s26, 128
    s_and_b32 s26, s26, 0x3ff
    s_add_u32 s27, s27, 128
    buffer_load_dwordx4 v148, s[44:47], s27 offen offset:0 lds
    ds_read_b128 v[124:127], v157 offset:0
    ds_read_b64_tr_b16 a[248:249], v160 offset:22528
    ds_read_b64_tr_b16 a[250:251], v160 offset:23040
    s_waitcnt lgkmcnt(10)
    v_mfma_f32_32x32x16_bf16 v[192:207], a[232:235], v[116:119], v[192:207]
    buffer_load_dwordx4 v149, s[44:47], s27 offen offset:1024 lds
    ds_read_b64_tr_b16 a[252:253], v161 offset:22528
    ds_read_b64_tr_b16 a[254:255], v161 offset:23040
    s_waitcnt lgkmcnt(10)
    v_mfma_f32_32x32x16_bf16 v[208:223], a[236:239], v[116:119], v[208:223]
    s_mul_i32 s27, s26, 1792
    s_add_u32 m0, s12, 131072
    s_add_u32 s26, s26, 128
    s_and_b32 s26, s26, 0x3ff
    s_add_u32 s27, s27, 128
    buffer_load_dwordx4 v148, s[44:47], s27 offen offset:0 lds
    s_waitcnt lgkmcnt(7)
    v_mfma_f32_32x32x16_bf16 v[192:207], a[240:243], v[120:123], v[192:207]
    buffer_load_dwordx4 v149, s[44:47], s27 offen offset:1024 lds
    s_waitcnt lgkmcnt(5)
    v_mfma_f32_32x32x16_bf16 v[208:223], a[244:247], v[120:123], v[208:223]
    s_waitcnt vmcnt(10)
    s_barrier
    s_mul_i32 s27, s26, 1792
    s_add_u32 m0, s12, 139264
    s_add_u32 s26, s26, 128
    s_and_b32 s26, s26, 0x3ff
    s_add_u32 s27, s27, 128
    buffer_load_dwordx4 v148, s[44:47], s27 offen offset:0 lds
    ds_read_b128 v[128:131], v154 offset:24576
    ds_read_b64_tr_b16 a[224:225], v160 offset:28672
    ds_read_b64_tr_b16 a[226:227], v160 offset:29184
    ds_read_b64_tr_b16 a[228:229], v161 offset:28672
    ds_read_b64_tr_b16 a[230:231], v161 offset:29184
    ds_read_b128 v[132:135], v155 offset:24576
    ds_read_b64_tr_b16 a[232:233], v160 offset:34816
    ds_read_b64_tr_b16 a[234:235], v160 offset:35328
    s_waitcnt lgkmcnt(10)
    v_mfma_f32_32x32x16_bf16 v[192:207], a[248:251], v[124:127], v[192:207]
    buffer_load_dwordx4 v149, s[44:47], s27 offen offset:1024 lds
    ds_read_b64_tr_b16 a[236:237], v161 offset:34816
    ds_read_b64_tr_b16 a[238:239], v161 offset:35328
    s_waitcnt lgkmcnt(10)
    v_mfma_f32_32x32x16_bf16 v[208:223], a[252:255], v[124:127], v[208:223]
    s_mul_i32 s27, s26, 1792
    s_add_u32 m0, s12, 147456
    s_add_u32 s26, s26, 128
    s_and_b32 s26, s26, 0x3ff
    s_add_u32 s27, s27, 128
    buffer_load_dwordx4 v148, s[44:47], s27 offen offset:0 lds
    ds_read_b128 v[136:139], v156 offset:24576
    ds_read_b64_tr_b16 a[240:241], v160 offset:40960
    ds_read_b64_tr_b16 a[242:243], v160 offset:41472
    s_waitcnt lgkmcnt(10)
    v_mfma_f32_32x32x16_bf16 v[192:207], a[224:227], v[128:131], v[192:207]
    buffer_load_dwordx4 v149, s[44:47], s27 offen offset:1024 lds
    ds_read_b64_tr_b16 a[244:245], v161 offset:40960
    ds_read_b64_tr_b16 a[246:247], v161 offset:41472
    s_waitcnt lgkmcnt(10)
    v_mfma_f32_32x32x16_bf16 v[208:223], a[228:231], v[128:131], v[208:223]
    s_mul_i32 s27, s26, 1792
    s_add_u32 m0, s12, 155648
    s_add_u32 s26, s26, 128
    s_and_b32 s26, s26, 0x3ff
    s_add_u32 s27, s27, 128
    buffer_load_dwordx4 v148, s[44:47], s27 offen offset:0 lds
    ds_read_b128 v[140:143], v157 offset:24576
    ds_read_b64_tr_b16 a[248:249], v160 offset:47104
    ds_read_b64_tr_b16 a[250:251], v160 offset:47616
    s_waitcnt lgkmcnt(10)
    v_mfma_f32_32x32x16_bf16 v[192:207], a[232:235], v[132:135], v[192:207]
    buffer_load_dwordx4 v149, s[44:47], s27 offen offset:1024 lds
    ds_read_b64_tr_b16 a[252:253], v161 offset:47104
    ds_read_b64_tr_b16 a[254:255], v161 offset:47616
    s_waitcnt lgkmcnt(10)
    v_mfma_f32_32x32x16_bf16 v[208:223], a[236:239], v[132:135], v[208:223]
    s_waitcnt lgkmcnt(7)
    v_mfma_f32_32x32x16_bf16 v[192:207], a[240:243], v[136:139], v[192:207]
    s_waitcnt lgkmcnt(5)
    v_mfma_f32_32x32x16_bf16 v[208:223], a[244:247], v[136:139], v[208:223]
    s_waitcnt vmcnt(12)
    s_barrier
    ds_read_b64_tr_b16 a[224:225], v162 offset:0
    ds_read_b64_tr_b16 a[226:227], v162 offset:512
    ds_read_b64_tr_b16 a[228:229], v162 offset:2048
    ds_read_b64_tr_b16 a[230:231], v162 offset:2560
    ds_read_b64_tr_b16 a[232:233], v162 offset:4096
    ds_read_b64_tr_b16 a[234:235], v162 offset:4608
    s_waitcnt lgkmcnt(8)
    v_mfma_f32_32x32x16_bf16 v[192:207], a[248:251], v[140:143], v[192:207]
    ds_read_b64_tr_b16 a[236:237], v162 offset:6144
    ds_read_b64_tr_b16 a[238:239], v162 offset:6656
    s_waitcnt lgkmcnt(8)
    v_mfma_f32_32x32x16_bf16 v[208:223], a[252:255], v[140:143], v[208:223]
    ds_read_b64_tr_b16 a[240:241], v162 offset:8192
    ds_read_b64_tr_b16 a[242:243], v162 offset:8704
    s_waitcnt lgkmcnt(8)
    v_mfma_f32_32x32x16_bf16 v[224:239], a[224:227], v[16:19], 0
    ds_read_b64_tr_b16 a[244:245], v162 offset:10240
    ds_read_b64_tr_b16 a[246:247], v162 offset:10752
    s_waitcnt lgkmcnt(8)
    v_mfma_f32_32x32x16_bf16 v[224:239], a[228:231], v[20:23], v[224:239]
    ds_read_b64_tr_b16 a[248:249], v162 offset:12288
    ds_read_b64_tr_b16 a[250:251], v162 offset:12800
    s_waitcnt lgkmcnt(8)
    v_mfma_f32_32x32x16_bf16 v[224:239], a[232:235], v[24:27], v[224:239]
    v_cvt_pk_bf16_f32 v164, v192, v193
    v_cvt_pk_bf16_f32 v165, v194, v195
    ds_read_b64_tr_b16 a[252:253], v162 offset:14336
    ds_read_b64_tr_b16 a[254:255], v162 offset:14848
    s_waitcnt lgkmcnt(8)
    v_mfma_f32_32x32x16_bf16 v[224:239], a[236:239], v[28:31], v[224:239]
    v_cvt_pk_bf16_f32 v166, v196, v197
    v_cvt_pk_bf16_f32 v167, v198, v199
    ds_read_b64_tr_b16 a[224:225], v163 offset:0
    ds_read_b64_tr_b16 a[226:227], v163 offset:512
    s_waitcnt lgkmcnt(8)
    v_mfma_f32_32x32x16_bf16 v[224:239], a[240:243], v[32:35], v[224:239]
    v_pk_max_i16 v164, v164, 0
    v_pk_max_i16 v165, v165, 0
    ds_read_b64_tr_b16 a[228:229], v163 offset:2048
    ds_read_b64_tr_b16 a[230:231], v163 offset:2560
    s_waitcnt lgkmcnt(8)
    v_mfma_f32_32x32x16_bf16 v[224:239], a[244:247], v[36:39], v[224:239]
    v_pk_max_i16 v166, v166, 0
    v_pk_max_i16 v167, v167, 0
    buffer_store_dwordx4 v[164:167], v2, s[56:59], 0 offen offset:0 sc1
    ds_read_b64_tr_b16 a[232:233], v163 offset:4096
    ds_read_b64_tr_b16 a[234:235], v163 offset:4608
    s_waitcnt lgkmcnt(8)
    v_mfma_f32_32x32x16_bf16 v[224:239], a[248:251], v[40:43], v[224:239]
    v_cvt_pk_bf16_f32 v168, v200, v201
    v_cvt_pk_bf16_f32 v169, v202, v203
    s_waitcnt lgkmcnt(6)
    v_mfma_f32_32x32x16_bf16 v[224:239], a[252:255], v[44:47], v[224:239]
    v_cvt_pk_bf16_f32 v170, v204, v205
    v_cvt_pk_bf16_f32 v171, v206, v207
    s_waitcnt lgkmcnt(4)
    v_mfma_f32_32x32x16_bf16 v[240:255], a[224:227], v[16:19], 0
    s_waitcnt vmcnt(9)
    s_barrier
    v_pk_max_i16 v168, v168, 0
    v_pk_max_i16 v169, v169, 0
    s_add_u32 m0, s28, 0
    s_nop 0
    buffer_load_dwordx4 v4, s[48:51], s29 offen offset:0 lds
    ds_read_b64_tr_b16 a[236:237], v162 offset:16384
    ds_read_b64_tr_b16 a[238:239], v162 offset:16896
    ds_read_b64_tr_b16 a[240:241], v162 offset:18432
    ds_read_b64_tr_b16 a[242:243], v162 offset:18944
    ds_read_b64_tr_b16 a[244:245], v162 offset:20480
    ds_read_b64_tr_b16 a[246:247], v162 offset:20992
    s_waitcnt lgkmcnt(8)
    v_mfma_f32_32x32x16_bf16 v[240:255], a[228:231], v[20:23], v[240:255]
    v_pk_max_i16 v170, v170, 0
    v_pk_max_i16 v171, v171, 0
    ds_read_b64_tr_b16 a[248:249], v162 offset:22528
    ds_read_b64_tr_b16 a[250:251], v162 offset:23040
    s_waitcnt lgkmcnt(8)
    v_mfma_f32_32x32x16_bf16 v[240:255], a[232:235], v[24:27], v[240:255]
    buffer_load_dwordx4 v5, s[48:51], s29 offen offset:1024 lds
    ds_read_b64_tr_b16 a[252:253], v162 offset:24576
    ds_read_b64_tr_b16 a[254:255], v162 offset:25088
    s_waitcnt lgkmcnt(8)
    v_mfma_f32_32x32x16_bf16 v[224:239], a[236:239], v[48:51], v[224:239]
    ds_read_b64_tr_b16 a[224:225], v162 offset:26624
    ds_read_b64_tr_b16 a[226:227], v162 offset:27136
    s_waitcnt lgkmcnt(8)
    v_mfma_f32_32x32x16_bf16 v[224:239], a[240:243], v[52:55], v[224:239]
    buffer_load_dwordx4 v6, s[48:51], s29 offen offset:2048 lds
    ds_read_b64_tr_b16 a[228:229], v162 offset:28672
    ds_read_b64_tr_b16 a[230:231], v162 offset:29184
    s_waitcnt lgkmcnt(8)
    v_mfma_f32_32x32x16_bf16 v[224:239], a[244:247], v[56:59], v[224:239]
    ds_read_b64_tr_b16 a[232:233], v162 offset:30720
    ds_read_b64_tr_b16 a[234:235], v162 offset:31232
    s_waitcnt lgkmcnt(8)
    v_mfma_f32_32x32x16_bf16 v[224:239], a[248:251], v[60:63], v[224:239]
    ds_read_b64_tr_b16 a[236:237], v163 offset:6144
    ds_read_b64_tr_b16 a[238:239], v163 offset:6656
    s_waitcnt lgkmcnt(8)
    v_mfma_f32_32x32x16_bf16 v[224:239], a[252:255], v[64:67], v[224:239]
    buffer_store_dwordx4 v[168:171], v2, s[56:59], 0 offen offset:512 sc1
    ds_read_b64_tr_b16 a[240:241], v163 offset:8192
    ds_read_b64_tr_b16 a[242:243], v163 offset:8704
    s_waitcnt lgkmcnt(8)
    v_mfma_f32_32x32x16_bf16 v[224:239], a[224:227], v[68:71], v[224:239]
    v_cvt_pk_bf16_f32 v172, v208, v209
    v_cvt_pk_bf16_f32 v173, v210, v211
    ds_read_b64_tr_b16 a[244:245], v163 offset:10240
    ds_read_b64_tr_b16 a[246:247], v163 offset:10752
    s_waitcnt lgkmcnt(8)
    v_mfma_f32_32x32x16_bf16 v[224:239], a[228:231], v[72:75], v[224:239]
    v_cvt_pk_bf16_f32 v174, v212, v213
    v_cvt_pk_bf16_f32 v175, v214, v215
    buffer_load_dwordx4 v7, s[48:51], s29 offen offset:3072 lds
    s_add_u32 s29, s29, 32768
    s_waitcnt lgkmcnt(6)
    v_mfma_f32_32x32x16_bf16 v[224:239], a[232:235], v[76:79], v[224:239]
    v_pk_max_i16 v172, v172, 0
    v_pk_max_i16 v173, v173, 0
    s_waitcnt lgkmcnt(4)
    v_mfma_f32_32x32x16_bf16 v[240:255], a[236:239], v[28:31], v[240:255]
    s_waitcnt vmcnt(10)
    s_barrier
    v_pk_max_i16 v174, v174, 0
    v_pk_max_i16 v175, v175, 0
    s_add_u32 m0, s28, 4096
    s_nop 0
    buffer_load_dwordx4 v4, s[48:51], s29 offen offset:0 lds
    ds_read_b64_tr_b16 a[248:249], v162 offset:32768
    ds_read_b64_tr_b16 a[250:251], v162 offset:33280
    ds_read_b64_tr_b16 a[252:253], v162 offset:34816
    ds_read_b64_tr_b16 a[254:255], v162 offset:35328
    ds_read_b64_tr_b16 a[224:225], v162 offset:36864
    ds_read_b64_tr_b16 a[226:227], v162 offset:37376
    s_waitcnt lgkmcnt(8)
    v_mfma_f32_32x32x16_bf16 v[240:255], a[240:243], v[32:35], v[240:255]
    ds_read_b64_tr_b16 a[228:229], v162 offset:38912
    ds_read_b64_tr_b16 a[230:231], v162 offset:39424
    s_waitcnt lgkmcnt(8)
    v_mfma_f32_32x32x16_bf16 v[240:255], a[244:247], v[36:39], v[240:255]
    ds_read_b64_tr_b16 a[232:233], v162 offset:40960
    ds_read_b64_tr_b16 a[234:235], v162 offset:41472
    s_waitcnt lgkmcnt(8)
    v_mfma_f32_32x32x16_bf16 v[224:239], a[248:251], v[80:83], v[224:239]
    buffer_load_dwordx4 v5, s[48:51], s29 offen offset:1024 lds
    ds_read_b64_tr_b16 a[236:237], v162 offset:43008
    ds_read_b64_tr_b16 a[238:239], v162 offset:43520
    s_waitcnt lgkmcnt(8)
    v_mfma_f32_32x32x16_bf16 v[224:239], a[252:255], v[84:87], v[224:239]
    ds_read_b64_tr_b16 a[240:241], v162 offset:45056
    ds_read_b64_tr_b16 a[242:243], v162 offset:45568
    s_waitcnt lgkmcnt(8)
    v_mfma_f32_32x32x16_bf16 v[224:239], a[224:227], v[88:91], v[224:239]
    buffer_store_dwordx4 v[172:175], v2, s[56:59], 0 offen offset:2048 sc1
    ds_read_b64_tr_b16 a[244:245], v162 offset:47104
    ds_read_b64_tr_b16 a[246:247], v162 offset:47616
    s_waitcnt lgkmcnt(8)
    v_mfma_f32_32x32x16_bf16 v[224:239], a[228:231], v[92:95], v[224:239]
    v_cvt_pk_bf16_f32 v176, v216, v217
    v_cvt_pk_bf16_f32 v177, v218, v219
    ds_read_b64_tr_b16 a[248:249], v163 offset:12288
    ds_read_b64_tr_b16 a[250:251], v163 offset:12800
    s_waitcnt lgkmcnt(8)
    v_mfma_f32_32x32x16_bf16 v[224:239], a[232:235], v[96:99], v[224:239]
    v_cvt_pk_bf16_f32 v178, v220, v221
    v_cvt_pk_bf16_f32 v179, v222, v223
    ds_read_b64_tr_b16 a[252:253], v163 offset:14336
    ds_read_b64_tr_b16 a[254:255], v163 offset:14848
    s_waitcnt lgkmcnt(8)
    v_mfma_f32_32x32x16_bf16 v[224:239], a[236:239], v[100:103], v[224:239]
    v_pk_max_i16 v176, v176, 0
    v_pk_max_i16 v177, v177, 0
    buffer_load_dwordx4 v6, s[48:51], s29 offen offset:2048 lds
    ds_read_b64_tr_b16 a[224:225], v163 offset:16384
    ds_read_b64_tr_b16 a[226:227], v163 offset:16896
    s_waitcnt lgkmcnt(8)
    v_mfma_f32_32x32x16_bf16 v[224:239], a[240:243], v[104:107], v[224:239]
    v_pk_max_i16 v178, v178, 0
    v_pk_max_i16 v179, v179, 0
    s_waitcnt lgkmcnt(6)
    v_mfma_f32_32x32x16_bf16 v[224:239], a[244:247], v[108:111], v[224:239]
    buffer_load_dwordx4 v7, s[48:51], s29 offen offset:3072 lds
    s_add_u32 s29, s29, 32768
    s_waitcnt lgkmcnt(4)
    v_mfma_f32_32x32x16_bf16 v[240:255], a[248:251], v[40:43], v[240:255]
    s_waitcnt vmcnt(11)
    s_barrier
    ds_read_b64_tr_b16 a[228:229], v162 offset:49152
    ds_read_b64_tr_b16 a[230:231], v162 offset:49664
    ds_read_b64_tr_b16 a[232:233], v162 offset:51200
    ds_read_b64_tr_b16 a[234:235], v162 offset:51712
    ds_read_b64_tr_b16 a[236:237], v162 offset:53248
    ds_read_b64_tr_b16 a[238:239], v162 offset:53760
    s_waitcnt lgkmcnt(8)
    v_mfma_f32_32x32x16_bf16 v[240:255], a[252:255], v[44:47], v[240:255]
    s_add_u32 m0, s28, 32768
    s_nop 0
    buffer_load_dwordx4 v4, s[48:51], s29 offen offset:0 lds
    ds_read_b64_tr_b16 a[240:241], v162 offset:55296
    ds_read_b64_tr_b16 a[242:243], v162 offset:55808
    s_waitcnt lgkmcnt(8)
    v_mfma_f32_32x32x16_bf16 v[240:255], a[224:227], v[48:51], v[240:255]
    ds_read_b64_tr_b16 a[244:245], v162 offset:57344
    ds_read_b64_tr_b16 a[246:247], v162 offset:57856
    s_waitcnt lgkmcnt(8)
    v_mfma_f32_32x32x16_bf16 v[224:239], a[228:231], v[112:115], v[224:239]
    ds_read_b64_tr_b16 a[248:249], v162 offset:59392
    ds_read_b64_tr_b16 a[250:251], v162 offset:59904
    s_waitcnt lgkmcnt(8)
    v_mfma_f32_32x32x16_bf16 v[224:239], a[232:235], v[116:119], v[224:239]
    buffer_store_dwordx4 v[176:179], v2, s[56:59], 0 offen offset:2560 sc1
    ds_read_b64_tr_b16 a[252:253], v162 offset:61440
    ds_read_b64_tr_b16 a[254:255], v162 offset:61952
    s_waitcnt lgkmcnt(8)
    v_mfma_f32_32x32x16_bf16 v[224:239], a[236:239], v[120:123], v[224:239]
    ds_read_b64_tr_b16 a[224:225], v162 offset:63488
    ds_read_b64_tr_b16 a[226:227], v162 offset:64000
    s_waitcnt lgkmcnt(8)
    v_mfma_f32_32x32x16_bf16 v[224:239], a[240:243], v[124:127], v[224:239]
    buffer_load_dwordx4 v5, s[48:51], s29 offen offset:1024 lds
    ds_read_b64_tr_b16 a[228:229], v163 offset:18432
    ds_read_b64_tr_b16 a[230:231], v163 offset:18944
    s_waitcnt lgkmcnt(8)
    v_mfma_f32_32x32x16_bf16 v[224:239], a[244:247], v[128:131], v[224:239]
    ds_read_b64_tr_b16 a[232:233], v163 offset:20480
    ds_read_b64_tr_b16 a[234:235], v163 offset:20992
    s_waitcnt lgkmcnt(8)
    v_mfma_f32_32x32x16_bf16 v[224:239], a[248:251], v[132:135], v[224:239]
    ds_read_b64_tr_b16 a[236:237], v163 offset:22528
    ds_read_b64_tr_b16 a[238:239], v163 offset:23040
    s_waitcnt lgkmcnt(8)
    v_mfma_f32_32x32x16_bf16 v[224:239], a[252:255], v[136:139], v[224:239]
    buffer_load_dwordx4 v6, s[48:51], s29 offen offset:2048 lds
    ds_read_b64_tr_b16 a[240:241], v163 offset:24576
    ds_read_b64_tr_b16 a[242:243], v163 offset:25088
    s_waitcnt lgkmcnt(8)
    v_mfma_f32_32x32x16_bf16 v[224:239], a[224:227], v[140:143], v[224:239]
    ds_read_b64_tr_b16 a[244:245], v163 offset:26624
    ds_read_b64_tr_b16 a[246:247], v163 offset:27136
    s_waitcnt lgkmcnt(8)
    v_mfma_f32_32x32x16_bf16 v[240:255], a[228:231], v[52:55], v[240:255]
    buffer_load_dwordx4 v7, s[48:51], s29 offen offset:3072 lds
    s_add_u32 s29, s29, 32768
    ds_read_b64_tr_b16 a[248:249], v163 offset:28672
    ds_read_b64_tr_b16 a[250:251], v163 offset:29184
    s_waitcnt lgkmcnt(8)
    v_mfma_f32_32x32x16_bf16 v[240:255], a[232:235], v[56:59], v[240:255]
    ds_read_b64_tr_b16 a[252:253], v163 offset:30720
    ds_read_b64_tr_b16 a[254:255], v163 offset:31232
    s_waitcnt lgkmcnt(8)
    v_mfma_f32_32x32x16_bf16 v[240:255], a[236:239], v[60:63], v[240:255]
    s_add_u32 m0, s28, 36864
    s_nop 0
    buffer_load_dwordx4 v4, s[48:51], s29 offen offset:0 lds
    ds_read_b64_tr_b16 a[224:225], v163 offset:32768
    ds_read_b64_tr_b16 a[226:227], v163 offset:33280
    s_waitcnt lgkmcnt(8)
    v_mfma_f32_32x32x16_bf16 v[240:255], a[240:243], v[64:67], v[240:255]
    v_cvt_pk_bf16_f32 v164, v224, v225
    v_cvt_pk_bf16_f32 v165, v226, v227
    ds_read_b64_tr_b16 a[228:229], v163 offset:34816
    ds_read_b64_tr_b16 a[230:231], v163 offset:35328
    s_waitcnt lgkmcnt(8)
    v_mfma_f32_32x32x16_bf16 v[240:255], a[244:247], v[68:71], v[240:255]
    v_cvt_pk_bf16_f32 v166, v228, v229
    v_cvt_pk_bf16_f32 v167, v230, v231
    ds_read_b64_tr_b16 a[232:233], v163 offset:36864
    ds_read_b64_tr_b16 a[234:235], v163 offset:37376
    s_waitcnt lgkmcnt(8)
    v_mfma_f32_32x32x16_bf16 v[240:255], a[248:251], v[72:75], v[240:255]
    v_pk_max_i16 v164, v164, 0
    v_pk_max_i16 v165, v165, 0
    buffer_load_dwordx4 v5, s[48:51], s29 offen offset:1024 lds
    ds_read_b64_tr_b16 a[236:237], v163 offset:38912
    ds_read_b64_tr_b16 a[238:239], v163 offset:39424
    s_waitcnt lgkmcnt(8)
    v_mfma_f32_32x32x16_bf16 v[240:255], a[252:255], v[76:79], v[240:255]
    v_pk_max_i16 v166, v166, 0
    v_pk_max_i16 v167, v167, 0
    ds_read_b64_tr_b16 a[240:241], v163 offset:40960
    ds_read_b64_tr_b16 a[242:243], v163 offset:41472
    s_waitcnt lgkmcnt(8)
    v_mfma_f32_32x32x16_bf16 v[240:255], a[224:227], v[80:83], v[240:255]
    buffer_store_dwordx4 v[164:167], v2, s[56:59], s13 offen offset:0 sc1
    ds_read_b64_tr_b16 a[244:245], v163 offset:43008
    ds_read_b64_tr_b16 a[246:247], v163 offset:43520
    s_waitcnt lgkmcnt(8)
    v_mfma_f32_32x32x16_bf16 v[240:255], a[228:231], v[84:87], v[240:255]
    v_cvt_pk_bf16_f32 v168, v232, v233
    v_cvt_pk_bf16_f32 v169, v234, v235
    ds_read_b64_tr_b16 a[248:249], v163 offset:45056
    ds_read_b64_tr_b16 a[250:251], v163 offset:45568
    s_waitcnt lgkmcnt(8)
    v_mfma_f32_32x32x16_bf16 v[240:255], a[232:235], v[88:91], v[240:255]
    v_cvt_pk_bf16_f32 v170, v236, v237
    v_cvt_pk_bf16_f32 v171, v238, v239
    ds_read_b64_tr_b16 a[252:253], v163 offset:47104
    ds_read_b64_tr_b16 a[254:255], v163 offset:47616
    s_waitcnt lgkmcnt(8)
    v_mfma_f32_32x32x16_bf16 v[240:255], a[236:239], v[92:95], v[240:255]
    v_pk_max_i16 v168, v168, 0
    v_pk_max_i16 v169, v169, 0
    buffer_load_dwordx4 v6, s[48:51], s29 offen offset:2048 lds
    ds_read_b64_tr_b16 a[224:225], v163 offset:49152
    ds_read_b64_tr_b16 a[226:227], v163 offset:49664
    s_waitcnt lgkmcnt(8)
    v_mfma_f32_32x32x16_bf16 v[240:255], a[240:243], v[96:99], v[240:255]
    v_pk_max_i16 v170, v170, 0
    v_pk_max_i16 v171, v171, 0
    ds_read_b64_tr_b16 a[228:229], v163 offset:51200
    ds_read_b64_tr_b16 a[230:231], v163 offset:51712
    s_waitcnt lgkmcnt(8)
    v_mfma_f32_32x32x16_bf16 v[240:255], a[244:247], v[100:103], v[240:255]
    buffer_load_dwordx4 v7, s[48:51], s29 offen offset:3072 lds
    s_add_u32 s29, s29, 32768
    ds_read_b64_tr_b16 a[232:233], v163 offset:53248
    ds_read_b64_tr_b16 a[234:235], v163 offset:53760
    s_waitcnt lgkmcnt(8)
    v_mfma_f32_32x32x16_bf16 v[240:255], a[248:251], v[104:107], v[240:255]
    ds_read_b64_tr_b16 a[236:237], v163 offset:55296
    ds_read_b64_tr_b16 a[238:239], v163 offset:55808
    s_waitcnt lgkmcnt(8)
    v_mfma_f32_32x32x16_bf16 v[240:255], a[252:255], v[108:111], v[240:255]
    s_add_u32 m0, s28, 65536
    s_nop 0
    buffer_load_dwordx4 v4, s[48:51], s29 offen offset:0 lds
    ds_read_b64_tr_b16 a[240:241], v163 offset:57344
    ds_read_b64_tr_b16 a[242:243], v163 offset:57856
    s_waitcnt lgkmcnt(8)
    v_mfma_f32_32x32x16_bf16 v[240:255], a[224:227], v[112:115], v[240:255]
    ds_read_b64_tr_b16 a[244:245], v163 offset:59392
    ds_read_b64_tr_b16 a[246:247], v163 offset:59904
    s_waitcnt lgkmcnt(8)
    v_mfma_f32_32x32x16_bf16 v[240:255], a[228:231], v[116:119], v[240:255]
    ds_read_b64_tr_b16 a[248:249], v163 offset:61440
    ds_read_b64_tr_b16 a[250:251], v163 offset:61952
    s_waitcnt lgkmcnt(8)
    v_mfma_f32_32x32x16_bf16 v[240:255], a[232:235], v[120:123], v[240:255]
    buffer_store_dwordx4 v[168:171], v2, s[56:59], s13 offen offset:512 sc1
    ds_read_b64_tr_b16 a[252:253], v163 offset:63488
    ds_read_b64_tr_b16 a[254:255], v163 offset:64000
    s_waitcnt lgkmcnt(8)
    v_mfma_f32_32x32x16_bf16 v[240:255], a[236:239], v[124:127], v[240:255]
    s_waitcnt lgkmcnt(6)
    v_mfma_f32_32x32x16_bf16 v[240:255], a[240:243], v[128:131], v[240:255]
    buffer_load_dwordx4 v5, s[48:51], s29 offen offset:1024 lds
    s_waitcnt lgkmcnt(4)
    v_mfma_f32_32x32x16_bf16 v[240:255], a[244:247], v[132:135], v[240:255]
    s_waitcnt lgkmcnt(0)
    s_barrier
    v_mfma_f32_32x32x16_bf16 v[240:255], a[248:251], v[136:139], v[240:255]
    v_mfma_f32_32x32x16_bf16 v[240:255], a[252:255], v[140:143], v[240:255]
    buffer_load_dwordx4 v6, s[48:51], s29 offen offset:2048 lds
    s_add_u32 s24, s24, 454962503
    s_addc_u32 s25, s25, 982451653
    s_nop 7
    s_nop 1
    v_cvt_pk_bf16_f32 v172, v240, v241
    v_cvt_pk_bf16_f32 v173, v242, v243
    v_cvt_pk_bf16_f32 v174, v244, v245
    v_cvt_pk_bf16_f32 v175, v246, v247
    v_pk_max_i16 v172, v172, 0
    v_pk_max_i16 v173, v173, 0
    v_pk_max_i16 v174, v174, 0
    v_pk_max_i16 v175, v175, 0
    buffer_store_dwordx4 v[172:175], v2, s[56:59], s13 offen offset:2048 sc1
    v_cvt_pk_bf16_f32 v176, v248, v249
    v_cvt_pk_bf16_f32 v177, v250, v251
    v_cvt_pk_bf16_f32 v178, v252, v253
    v_cvt_pk_bf16_f32 v179, v254, v255
    v_pk_max_i16 v176, v176, 0
    v_pk_max_i16 v177, v177, 0
    v_pk_max_i16 v178, v178, 0
    v_pk_max_i16 v179, v179, 0
    buffer_store_dwordx4 v[176:179], v2, s[56:59], s13 offen offset:2560 sc1
    buffer_load_dwordx4 v7, s[48:51], s29 offen offset:3072 lds
    s_add_u32 s29, s29, 32768
    s_add_u32 m0, s28, 69632
    s_nop 0
    buffer_load_dwordx4 v4, s[48:51], s29 offen offset:0 lds
    buffer_load_dwordx4 v5, s[48:51], s29 offen offset:1024 lds
    buffer_load_dwordx4 v6, s[48:51], s29 offen offset:2048 lds
    buffer_load_dwordx4 v7, s[48:51], s29 offen offset:3072 lds
    s_add_u32 s29, s29, 32768
    s_add_u32 m0, s28, 98304
    s_nop 0
    buffer_load_dwordx4 v4, s[48:51], s29 offen offset:0 lds
    buffer_load_dwordx4 v5, s[48:51], s29 offen offset:1024 lds
    buffer_load_dwordx4 v6, s[48:51], s29 offen offset:2048 lds
    buffer_load_dwordx4 v7, s[48:51], s29 offen offset:3072 lds
    s_add_u32 s29, s29, 32768
    s_add_u32 m0, s28, 102400
    s_nop 0
    buffer_load_dwordx4 v4, s[48:51], s29 offen offset:0 lds
    buffer_load_dwordx4 v5, s[48:51], s29 offen offset:1024 lds
    buffer_load_dwordx4 v6, s[48:51], s29 offen offset:2048 lds
    buffer_load_dwordx4 v7, s[48:51], s29 offen offset:3072 lds
    s_add_u32 s29, s29, 32768
    v_mov_b32 v164, s35
    v_mov_b32 v166, s24
    v_mov_b32 v167, s25
    s_waitcnt vmcnt(13)
    s_mov_b64 exec, 1
    buffer_store_dwordx2 v[166:167], v164, s[60:63], 0 offen sc1
    s_mov_b64 exec, -1
    s_add_u32 m0, s28, 131072
    s_nop 0
    buffer_load_dwordx4 v4, s[48:51], s29 offen offset:0 lds
    buffer_load_dwordx4 v5, s[48:51], s29 offen offset:1024 lds
    buffer_load_dwordx4 v6, s[48:51], s29 offen offset:2048 lds
    buffer_load_dwordx4 v7, s[48:51], s29 offen offset:3072 lds
    s_add_u32 s29, s29, 32768
    s_add_u32 m0, s28, 135168
    s_nop 0
    buffer_load_dwordx4 v4, s[48:51], s29 offen offset:0 lds
    buffer_load_dwordx4 v5, s[48:51], s29 offen offset:1024 lds
    buffer_load_dwordx4 v6, s[48:51], s29 offen offset:2048 lds
    buffer_load_dwordx4 v7, s[48:51], s29 offen offset:3072 lds
    s_add_u32 s29, s29, 32768
    ds_read_b64_tr_b16 a[0:1], v8 offset:0
    ds_read_b64_tr_b16 a[2:3], v8 offset:1024
    ds_read_b64_tr_b16 a[4:5], v9 offset:0
    ds_read_b64_tr_b16 a[6:7], v9 offset:1024
    ds_read_b64_tr_b16 a[8:9], v10 offset:0
    ds_read_b64_tr_b16 a[10:11], v10 offset:1024
    ds_read_b64_tr_b16 a[12:13], v11 offset:0
    ds_read_b64_tr_b16 a[14:15], v11 offset:1024
    ds_read_b64_tr_b16 a[16:17], v8 offset:4096
    ds_read_b64_tr_b16 a[18:19], v8 offset:5120
    ds_read_b64_tr_b16 a[20:21], v9 offset:4096
    ds_read_b64_tr_b16 a[22:23], v9 offset:5120
    ds_read_b64_tr_b16 a[24:25], v10 offset:4096
    ds_read_b64_tr_b16 a[26:27], v10 offset:5120
    ds_read_b64_tr_b16 a[28:29], v11 offset:4096
    ds_read_b64_tr_b16 a[30:31], v11 offset:5120
    s_waitcnt lgkmcnt(0)
    s_add_u32 m0, s28, 0
    s_nop 0
    buffer_load_dwordx4 v4, s[48:51], s29 offen offset:0 lds
    buffer_load_dwordx4 v5, s[48:51], s29 offen offset:1024 lds
    buffer_load_dwordx4 v6, s[48:51], s29 offen offset:2048 lds
    buffer_load_dwordx4 v7, s[48:51], s29 offen offset:3072 lds
    s_add_u32 s29, s29, 32768
    s_add_u32 m0, s28, 4096
    s_nop 0
    buffer_load_dwordx4 v4, s[48:51], s29 offen offset:0 lds
    buffer_load_dwordx4 v5, s[48:51], s29 offen offset:1024 lds
    buffer_load_dwordx4 v6, s[48:51], s29 offen offset:2048 lds
    buffer_load_dwordx4 v7, s[48:51], s29 offen offset:3072 lds
    s_add_u32 s29, s29, 32768
    v_mov_b32 v160, s24
    v_mov_b32 v161, s25
    s_mov_b64 exec, 0xff
    buffer_load_dwordx2 v[160:161], v14, s[60:63], 0 offen sc1
    s_mov_b64 exec, -1
    ds_read_b64_tr_b16 a[32:33], v8 offset:32768
    ds_read_b64_tr_b16 a[34:35], v8 offset:33792
    ds_read_b64_tr_b16 a[36:37], v9 offset:32768
    ds_read_b64_tr_b16 a[38:39], v9 offset:33792
    ds_read_b64_tr_b16 a[40:41], v10 offset:32768
    ds_read_b64_tr_b16 a[42:43], v10 offset:33792
    ds_read_b64_tr_b16 a[44:45], v11 offset:32768
    ds_read_b64_tr_b16 a[46:47], v11 offset:33792
    ds_read_b64_tr_b16 a[48:49], v8 offset:36864
    ds_read_b64_tr_b16 a[50:51], v8 offset:37888
    ds_read_b64_tr_b16 a[52:53], v9 offset:36864
    ds_read_b64_tr_b16 a[54:55], v9 offset:37888
    ds_read_b64_tr_b16 a[56:57], v10 offset:36864
    ds_read_b64_tr_b16 a[58:59], v10 offset:37888
    ds_read_b64_tr_b16 a[60:61], v11 offset:36864
    ds_read_b64_tr_b16 a[62:63], v11 offset:37888
    s_waitcnt lgkmcnt(0)
    s_add_u32 m0, s28, 32768
    s_nop 0
    buffer_load_dwordx4 v4, s[48:51], s29 offen offset:0 lds
    buffer_load_dwordx4 v5, s[48:51], s29 offen offset:1024 lds
    buffer_load_dwordx4 v6, s[48:51], s29 offen offset:2048 lds
    buffer_load_dwordx4 v7, s[48:51], s29 offen offset:3072 lds
    s_add_u32 s29, s29, 32768
    s_add_u32 m0, s28, 36864
    s_nop 0
    buffer_load_dwordx4 v4, s[48:51], s29 offen offset:0 lds
    buffer_load_dwordx4 v5, s[48:51], s29 offen offset:1024 lds
    buffer_load_dwordx4 v6, s[48:51], s29 offen offset:2048 lds
    buffer_load_dwordx4 v7, s[48:51], s29 offen offset:3072 lds
    s_add_u32 s29, s29, 32768
    v_lshl_add_u32 v2, v1, 4, s37
    s_mov_b32 s58, 7340032
    v_add_u32 v3, s68, v2
    s_waitcnt vmcnt(34)
    ds_read_b64_tr_b16 a[64:65], v12 offset:0
    ds_read_b64_tr_b16 a[66:67], v12 offset:1024
    ds_read_b64_tr_b16 a[68:69], v13 offset:0
    ds_read_b64_tr_b16 a[70:71], v13 offset:1024
    ds_read_b64_tr_b16 a[72:73], v0 offset:0
    ds_read_b64_tr_b16 a[74:75], v0 offset:1024
    ds_read_b64_tr_b16 a[76:77], v191 offset:0
    ds_read_b64_tr_b16 a[78:79], v191 offset:1024
    ds_read_b64_tr_b16 a[80:81], v12 offset:4096
    ds_read_b64_tr_b16 a[82:83], v12 offset:5120
    ds_read_b64_tr_b16 a[84:85], v13 offset:4096
    ds_read_b64_tr_b16 a[86:87], v13 offset:5120
    ds_read_b64_tr_b16 a[88:89], v0 offset:4096
    ds_read_b64_tr_b16 a[90:91], v0 offset:5120
    ds_read_b64_tr_b16 a[92:93], v191 offset:4096
    ds_read_b64_tr_b16 a[94:95], v191 offset:5120
    s_waitcnt vmcnt(26)
    ds_read_b64_tr_b16 a[96:97], v12 offset:32768
    ds_read_b64_tr_b16 a[98:99], v12 offset:33792
    ds_read_b64_tr_b16 a[100:101], v13 offset:32768
    ds_read_b64_tr_b16 a[102:103], v13 offset:33792
    ds_read_b64_tr_b16 a[104:105], v0 offset:32768
    ds_read_b64_tr_b16 a[106:107], v0 offset:33792
    ds_read_b64_tr_b16 a[108:109], v191 offset:32768
    ds_read_b64_tr_b16 a[110:111], v191 offset:33792
    ds_read_b64_tr_b16 a[112:113], v12 offset:36864
    ds_read_b64_tr_b16 a[114:115], v12 offset:37888
    ds_read_b64_tr_b16 a[116:117], v13 offset:36864
    ds_read_b64_tr_b16 a[118:119], v13 offset:37888
    ds_read_b64_tr_b16 a[120:121], v0 offset:36864
    ds_read_b64_tr_b16 a[122:123], v0 offset:37888
    ds_read_b64_tr_b16 a[124:125], v191 offset:36864
    ds_read_b64_tr_b16 a[126:127], v191 offset:37888
    s_waitcnt vmcnt(17)
    ds_read_b64_tr_b16 a[128:129], v180 offset:0
    ds_read_b64_tr_b16 a[130:131], v180 offset:1024
    ds_read_b64_tr_b16 a[132:133], v181 offset:0
    ds_read_b64_tr_b16 a[134:135], v181 offset:1024
    ds_read_b64_tr_b16 a[136:137], v182 offset:0
    ds_read_b64_tr_b16 a[138:139], v182 offset:1024
    ds_read_b64_tr_b16 a[140:141], v183 offset:0
    ds_read_b64_tr_b16 a[142:143], v183 offset:1024
    ds_read_b64_tr_b16 a[144:145], v180 offset:4096
    ds_read_b64_tr_b16 a[146:147], v180 offset:5120
    ds_read_b64_tr_b16 a[148:149], v181 offset:4096
    ds_read_b64_tr_b16 a[150:151], v181 offset:5120
    ds_read_b64_tr_b16 a[152:153], v182 offset:4096
    ds_read_b64_tr_b16 a[154:155], v182 offset:5120
    ds_read_b64_tr_b16 a[156:157], v183 offset:4096
    ds_read_b64_tr_b16 a[158:159], v183 offset:5120
    s_waitcnt vmcnt(8)
    v_cmp_ne_u64 vcc, s[24:25], v[160:161]
    s_cbranch_vccnz L_slow
L_go:
    buffer_load_dwordx4 v[16:19], v2, s[56:59], s90 offen offset:0 sc1
    buffer_load_dwordx4 v[20:23], v2, s[56:59], s90 offen offset:1024 sc1
    buffer_load_dwordx4 v[24:27], v2, s[56:59], s90 offen offset:2048 sc1
    buffer_load_dwordx4 v[28:31], v2, s[56:59], s90 offen offset:3072 sc1
    buffer_load_dwordx4 v[32:35], v2, s[56:59], s91 offen offset:0 sc1
    buffer_load_dwordx4 v[36:39], v2, s[56:59], s91 offen offset:1024 sc1
    buffer_load_dwordx4 v[40:43], v2, s[56:59], s91 offen offset:2048 sc1
    buffer_load_dwordx4 v[44:47], v2, s[56:59], s91 offen offset:3072 sc1
    buffer_load_dwordx4 v[48:51], v2, s[56:59], s92 offen offset:0 sc1
    buffer_load_dwordx4 v[52:55], v2, s[56:59], s92 offen offset:1024 sc1
    buffer_load_dwordx4 v[56:59], v2, s[56:59], s92 offen offset:2048 sc1
    buffer_load_dwordx4 v[60:63], v2, s[56:59], s92 offen offset:3072 sc1
    ds_read_b64_tr_b16 a[160:161], v8 offset:0
    ds_read_b64_tr_b16 a[162:163], v8 offset:1024
    ds_read_b64_tr_b16 a[164:165], v9 offset:0
    ds_read_b64_tr_b16 a[166:167], v9 offset:1024
    ds_read_b64_tr_b16 a[168:169], v10 offset:0
    ds_read_b64_tr_b16 a[170:171], v10 offset:1024
    ds_read_b64_tr_b16 a[172:173], v11 offset:0
    ds_read_b64_tr_b16 a[174:175], v11 offset:1024
    ds_read_b64_tr_b16 a[176:177], v8 offset:4096
    ds_read_b64_tr_b16 a[178:179], v8 offset:5120
    ds_read_b64_tr_b16 a[180:181], v9 offset:4096
    ds_read_b64_tr_b16 a[182:183], v9 offset:5120
    ds_read_b64_tr_b16 a[184:185], v10 offset:4096
    ds_read_b64_tr_b16 a[186:187], v10 offset:5120
    ds_read_b64_tr_b16 a[188:189], v11 offset:4096
    ds_read_b64_tr_b16 a[190:191], v11 offset:5120
    s_waitcnt vmcnt(12)
    ds_read_b64_tr_b16 a[192:193], v8 offset:32768
    ds_read_b64_tr_b16 a[194:195], v8 offset:33792
    ds_read_b64_tr_b16 a[196:197], v9 offset:32768
    ds_read_b64_tr_b16 a[198:199], v9 offset:33792
    ds_read_b64_tr_b16 a[200:201], v10 offset:32768
    ds_read_b64_tr_b16 a[202:203], v10 offset:33792
    ds_read_b64_tr_b16 a[204:205], v11 offset:32768
    ds_read_b64_tr_b16 a[206:207], v11 offset:33792
    ds_read_b64_tr_b16 a[208:209], v8 offset:36864
    ds_read_b64_tr_b16 a[210:211], v8 offset:37888
    ds_read_b64_tr_b16 a[212:213], v9 offset:36864
    ds_read_b64_tr_b16 a[214:215], v9 offset:37888
    ds_read_b64_tr_b16 a[216:217], v10 offset:36864
    ds_read_b64_tr_b16 a[218:219], v10 offset:37888
    ds_read_b64_tr_b16 a[220:221], v11 offset:36864
    ds_read_b64_tr_b16 a[222:223], v11 offset:37888
    s_waitcnt lgkmcnt(0)
    s_waitcnt vmcnt(11)
    v_mfma_f32_16x16x32_bf16 v[192:195], a[0:3], v[16:19], 0
    buffer_load_dwordx4 v[64:67], v2, s[56:59], s93 offen offset:0 sc1
    v_mfma_f32_16x16x32_bf16 v[196:199], a[4:7], v[16:19], 0
    v_mfma_f32_16x16x32_bf16 v[200:203], a[8:11], v[16:19], 0
    v_mfma_f32_16x16x32_bf16 v[204:207], a[12:15], v[16:19], 0
    s_waitcnt vmcnt(11)
    v_mfma_f32_16x16x32_bf16 v[208:211], a[0:3], v[20:23], 0
    buffer_load_dwordx4 v[68:71], v2, s[56:59], s93 offen offset:1024 sc1
    v_mfma_f32_16x16x32_bf16 v[212:215], a[4:7], v[20:23], 0
    v_mfma_f32_16x16x32_bf16 v[216:219], a[8:11], v[20:23], 0
    v_mfma_f32_16x16x32_bf16 v[220:223], a[12:15], v[20:23], 0
    s_waitcnt vmcnt(11)
    v_mfma_f32_16x16x32_bf16 v[192:195], a[16:19], v[24:27], v[192:195]
    buffer_load_dwordx4 v[72:75], v2, s[56:59], s93 offen offset:2048 sc1
    v_mfma_f32_16x16x32_bf16 v[196:199], a[20:23], v[24:27], v[196:199]
    v_mfma_f32_16x16x32_bf16 v[200:203], a[24:27], v[24:27], v[200:203]
    v_mfma_f32_16x16x32_bf16 v[204:207], a[28:31], v[24:27], v[204:207]
    s_waitcnt vmcnt(11)
    v_mfma_f32_16x16x32_bf16 v[208:211], a[16:19], v[28:31], v[208:211]
    buffer_load_dwordx4 v[76:79], v2, s[56:59], s93 offen offset:3072 sc1
    v_mfma_f32_16x16x32_bf16 v[212:215], a[20:23], v[28:31], v[212:215]
    v_mfma_f32_16x16x32_bf16 v[216:219], a[24:27], v[28:31], v[216:219]
    v_mfma_f32_16x16x32_bf16 v[220:223], a[28:31], v[28:31], v[220:223]
    s_waitcnt vmcnt(11)
    v_mfma_f32_16x16x32_bf16 v[192:195], a[32:35], v[32:35], v[192:195]
    buffer_load_dwordx4 v[80:83], v2, s[56:59], s94 offen offset:0 sc1
    v_mfma_f32_16x16x32_bf16 v[196:199], a[36:39], v[32:35], v[196:199]
    v_mfma_f32_16x16x32_bf16 v[200:203], a[40:43], v[32:35], v[200:203]
    v_mfma_f32_16x16x32_bf16 v[204:207], a[44:47], v[32:35], v[204:207]
    s_waitcnt vmcnt(11)
    v_mfma_f32_16x16x32_bf16 v[208:211], a[32:35], v[36:39], v[208:211]
    buffer_load_dwordx4 v[84:87], v2, s[56:59], s94 offen offset:1024 sc1
    v_mfma_f32_16x16x32_bf16 v[212:215], a[36:39], v[36:39], v[212:215]
    v_mfma_f32_16x16x32_bf16 v[216:219], a[40:43], v[36:39], v[216:219]
    v_mfma_f32_16x16x32_bf16 v[220:223], a[44:47], v[36:39], v[220:223]
    s_waitcnt vmcnt(11)
    v_mfma_f32_16x16x32_bf16 v[192:195], a[48:51], v[40:43], v[192:195]
    buffer_load_dwordx4 v[88:91], v2, s[56:59], s94 offen offset:2048 sc1
    v_mfma_f32_16x16x32_bf16 v[196:199], a[52:55], v[40:43], v[196:199]
    v_mfma_f32_16x16x32_bf16 v[200:203], a[56:59], v[40:43], v[200:203]
    v_mfma_f32_16x16x32_bf16 v[204:207], a[60:63], v[40:43], v[204:207]
    s_waitcnt vmcnt(11)
    v_mfma_f32_16x16x32_bf16 v[208:211], a[48:51], v[44:47], v[208:211]
    buffer_load_dwordx4 v[92:95], v2, s[56:59], s94 offen offset:3072 sc1
    v_mfma_f32_16x16x32_bf16 v[212:215], a[52:55], v[44:47], v[212:215]
    v_mfma_f32_16x16x32_bf16 v[216:219], a[56:59], v[44:47], v[216:219]
    v_mfma_f32_16x16x32_bf16 v[220:223], a[60:63], v[44:47], v[220:223]
    s_waitcnt vmcnt(11)
    v_mfma_f32_16x16x32_bf16 v[192:195], a[64:67], v[48:51], v[192:195]
    buffer_load_dwordx4 v[96:99], v2, s[56:59], s95 offen offset:0 sc1
    v_mfma_f32_16x16x32_bf16 v[196:199], a[68:71], v[48:51], v[196:199]
    v_mfma_f32_16x16x32_bf16 v[200:203], a[72:75], v[48:51], v[200:203]
    v_mfma_f32_16x16x32_bf16 v[204:207], a[76:79], v[48:51], v[204:207]
    s_waitcnt vmcnt(11)
    v_mfma_f32_16x16x32_bf16 v[208:211], a[64:67], v[52:55], v[208:211]
    buffer_load_dwordx4 v[100:103], v2, s[56:59], s95 offen offset:1024 sc1
    v_mfma_f32_16x16x32_bf16 v[212:215], a[68:71], v[52:55], v[212:215]
    v_mfma_f32_16x16x32_bf16 v[216:219], a[72:75], v[52:55], v[216:219]
    v_mfma_f32_16x16x32_bf16 v[220:223], a[76:79], v[52:55], v[220:223]
    s_waitcnt vmcnt(11)
    v_mfma_f32_16x16x32_bf16 v[192:195], a[80:83], v[56:59], v[192:195]
    buffer_load_dwordx4 v[104:107], v2, s[56:59], s95 offen offset:2048 sc1
    v_mfma_f32_16x16x32_bf16 v[196:199], a[84:87], v[56:59], v[196:199]
    v_mfma_f32_16x16x32_bf16 v[200:203], a[88:91], v[56:59], v[200:203]
    v_mfma_f32_16x16x32_bf16 v[204:207], a[92:95], v[56:59], v[204:207]
    s_waitcnt vmcnt(11)
    v_mfma_f32_16x16x32_bf16 v[208:211], a[80:83], v[60:63], v[208:211]
    buffer_load_dwordx4 v[108:111], v2, s[56:59], s95 offen offset:3072 sc1
    v_mfma_f32_16x16x32_bf16 v[212:215], a[84:87], v[60:63], v[212:215]
    v_mfma_f32_16x16x32_bf16 v[216:219], a[88:91], v[60:63], v[216:219]
    v_mfma_f32_16x16x32_bf16 v[220:223], a[92:95], v[60:63], v[220:223]
    s_waitcnt vmcnt(11)
    v_mfma_f32_16x16x32_bf16 v[192:195], a[96:99], v[64:67], v[192:195]
    buffer_load_dwordx4 v[112:115], v2, s[56:59], s4 offen offset:0 sc1
    v_mfma_f32_16x16x32_bf16 v[196:199], a[100:103], v[64:67], v[196:199]
    v_mfma_f32_16x16x32_bf16 v[200:203], a[104:107], v[64:67], v[200:203]
    v_mfma_f32_16x16x32_bf16 v[204:207], a[108:111], v[64:67], v[204:207]
    s_waitcnt vmcnt(11)
    v_mfma_f32_16x16x32_bf16 v[208:211], a[96:99], v[68:71], v[208:211]
    buffer_load_dwordx4 v[116:119], v2, s[56:59], s4 offen offset:1024 sc1
    v_mfma_f32_16x16x32_bf16 v[212:215], a[100:103], v[68:71], v[212:215]
    v_mfma_f32_16x16x32_bf16 v[216:219], a[104:107], v[68:71], v[216:219]
    v_mfma_f32_16x16x32_bf16 v[220:223], a[108:111], v[68:71], v[220:223]
    s_waitcnt vmcnt(11)
    v_mfma_f32_16x16x32_bf16 v[192:195], a[112:115], v[72:75], v[192:195]
    buffer_load_dwordx4 v[120:123], v2, s[56:59], s4 offen offset:2048 sc1
    v_mfma_f32_16x16x32_bf16 v[196:199], a[116:119], v[72:75], v[196:199]
    v_mfma_f32_16x16x32_bf16 v[200:203], a[120:123], v[72:75], v[200:203]
    v_mfma_f32_16x16x32_bf16 v[204:207], a[124:127], v[72:75], v[204:207]
    s_waitcnt vmcnt(11)
    v_mfma_f32_16x16x32_bf16 v[208:211], a[112:115], v[76:79], v[208:211]
    buffer_load_dwordx4 v[124:127], v2, s[56:59], s4 offen offset:3072 sc1
    v_mfma_f32_16x16x32_bf16 v[212:215], a[116:119], v[76:79], v[212:215]
    v_mfma_f32_16x16x32_bf16 v[216:219], a[120:123], v[76:79], v[216:219]
    v_mfma_f32_16x16x32_bf16 v[220:223], a[124:127], v[76:79], v[220:223]
    s_waitcnt vmcnt(11)
    v_mfma_f32_16x16x32_bf16 v[192:195], a[128:131], v[80:83], v[192:195]
    buffer_load_dwordx4 v[128:131], v3, s[56:59], s90 offen offset:0 sc1
    v_mfma_f32_16x16x32_bf16 v[196:199], a[132:135], v[80:83], v[196:199]
    v_mfma_f32_16x16x32_bf16 v[200:203], a[136:139], v[80:83], v[200:203]
    v_mfma_f32_16x16x32_bf16 v[204:207], a[140:143], v[80:83], v[204:207]
    s_waitcnt vmcnt(11)
    v_mfma_f32_16x16x32_bf16 v[208:211], a[128:131], v[84:87], v[208:211]
    buffer_load_dwordx4 v[132:135], v3, s[56:59], s90 offen offset:1024 sc1
    v_mfma_f32_16x16x32_bf16 v[212:215], a[132:135], v[84:87], v[212:215]
    v_mfma_f32_16x16x32_bf16 v[216:219], a[136:139], v[84:87], v[216:219]
    v_mfma_f32_16x16x32_bf16 v[220:223], a[140:143], v[84:87], v[220:223]
    s_waitcnt vmcnt(11)
    v_mfma_f32_16x16x32_bf16 v[192:195], a[144:147], v[88:91], v[192:195]
    buffer_load_dwordx4 v[136:139], v3, s[56:59], s90 offen offset:2048 sc1
    v_mfma_f32_16x16x32_bf16 v[196:199], a[148:151], v[88:91], v[196:199]
    v_mfma_f32_16x16x32_bf16 v[200:203], a[152:155], v[88:91], v[200:203]
    v_mfma_f32_16x16x32_bf16 v[204:207], a[156:159], v[88:91], v[204:207]
    s_waitcnt vmcnt(11)
    v_mfma_f32_16x16x32_bf16 v[208:211], a[144:147], v[92:95], v[208:211]
    buffer_load_dwordx4 v[140:143], v3, s[56:59], s90 offen offset:3072 sc1
    v_mfma_f32_16x16x32_bf16 v[212:215], a[148:151], v[92:95], v[212:215]
    v_mfma_f32_16x16x32_bf16 v[216:219], a[152:155], v[92:95], v[216:219]
    v_mfma_f32_16x16x32_bf16 v[220:223], a[156:159], v[92:95], v[220:223]
    s_waitcnt vmcnt(11)
    v_mfma_f32_16x16x32_bf16 v[192:195], a[160:163], v[96:99], v[192:195]
    buffer_load_dwordx4 v[144:147], v3, s[56:59], s91 offen offset:0 sc1
    v_mfma_f32_16x16x32_bf16 v[196:199], a[164:167], v[96:99], v[196:199]
    v_mfma_f32_16x16x32_bf16 v[200:203], a[168:171], v[96:99], v[200:203]
    v_mfma_f32_16x16x32_bf16 v[204:207], a[172:175], v[96:99], v[204:207]
    s_waitcnt vmcnt(11)
    v_mfma_f32_16x16x32_bf16 v[208:211], a[160:163], v[100:103], v[208:211]
    buffer_load_dwordx4 v[148:151], v3, s[56:59], s91 offen offset:1024 sc1
    v_mfma_f32_16x16x32_bf16 v[212:215], a[164:167], v[100:103], v[212:215]
    v_mfma_f32_16x16x32_bf16 v[216:219], a[168:171], v[100:103], v[216:219]
    v_mfma_f32_16x16x32_bf16 v[220:223], a[172:175], v[100:103], v[220:223]
    s_waitcnt vmcnt(11)
    v_mfma_f32_16x16x32_bf16 v[192:195], a[176:179], v[104:107], v[192:195]
    buffer_load_dwordx4 v[152:155], v3, s[56:59], s91 offen offset:2048 sc1
    v_mfma_f32_16x16x32_bf16 v[196:199], a[180:183], v[104:107], v[196:199]
    v_mfma_f32_16x16x32_bf16 v[200:203], a[184:187], v[104:107], v[200:203]
    v_mfma_f32_16x16x32_bf16 v[204:207], a[188:191], v[104:107], v[204:207]
    s_waitcnt vmcnt(11)
    v_mfma_f32_16x16x32_bf16 v[208:211], a[176:179], v[108:111], v[208:211]
    buffer_load_dwordx4 v[156:159], v3, s[56:59], s91 offen offset:3072 sc1
    v_mfma_f32_16x16x32_bf16 v[212:215], a[180:183], v[108:111], v[212:215]
    v_mfma_f32_16x16x32_bf16 v[216:219], a[184:187], v[108:111], v[216:219]
    v_mfma_f32_16x16x32_bf16 v[220:223], a[188:191], v[108:111], v[220:223]
    s_waitcnt vmcnt(11)
    v_mfma_f32_16x16x32_bf16 v[192:195], a[192:195], v[112:115], v[192:195]
    buffer_load_dwordx4 a[224:227], v3, s[56:59], s92 offen offset:0 sc1
    v_mfma_f32_16x16x32_bf16 v[196:199], a[196:199], v[112:115], v[196:199]
    v_mfma_f32_16x16x32_bf16 v[200:203], a[200:203], v[112:115], v[200:203]
    v_mfma_f32_16x16x32_bf16 v[204:207], a[204:207], v[112:115], v[204:207]
    s_waitcnt vmcnt(11)
    v_mfma_f32_16x16x32_bf16 v[208:211], a[192:195], v[116:119], v[208:211]
    buffer_load_dwordx4 a[228:231], v3, s[56:59], s92 offen offset:1024 sc1
    v_mfma_f32_16x16x32_bf16 v[212:215], a[196:199], v[116:119], v[212:215]
    v_mfma_f32_16x16x32_bf16 v[216:219], a[200:203], v[116:119], v[216:219]
    v_mfma_f32_16x16x32_bf16 v[220:223], a[204:207], v[116:119], v[220:223]
    s_waitcnt vmcnt(11)
    v_mfma_f32_16x16x32_bf16 v[192:195], a[208:211], v[120:123], v[192:195]
    buffer_load_dwordx4 a[232:235], v3, s[56:59], s92 offen offset:2048 sc1
    v_mfma_f32_16x16x32_bf16 v[196:199], a[212:215], v[120:123], v[196:199]
    v_mfma_f32_16x16x32_bf16 v[200:203], a[216:219], v[120:123], v[200:203]
    v_mfma_f32_16x16x32_bf16 v[204:207], a[220:223], v[120:123], v[204:207]
    s_waitcnt vmcnt(11)
    v_mfma_f32_16x16x32_bf16 v[208:211], a[208:211], v[124:127], v[208:211]
    buffer_load_dwordx4 a[236:239], v3, s[56:59], s92 offen offset:3072 sc1
    v_mfma_f32_16x16x32_bf16 v[212:215], a[212:215], v[124:127], v[212:215]
    v_mfma_f32_16x16x32_bf16 v[216:219], a[216:219], v[124:127], v[216:219]
    v_mfma_f32_16x16x32_bf16 v[220:223], a[220:223], v[124:127], v[220:223]
    s_waitcnt vmcnt(11)
    v_mfma_f32_16x16x32_bf16 v[224:227], a[0:3], v[128:131], 0
    buffer_load_dwordx4 a[240:243], v3, s[56:59], s93 offen offset:0 sc1
    v_mfma_f32_16x16x32_bf16 v[228:231], a[4:7], v[128:131], 0
    v_mfma_f32_16x16x32_bf16 v[232:235], a[8:11], v[128:131], 0
    v_mfma_f32_16x16x32_bf16 v[236:239], a[12:15], v[128:131], 0
    s_waitcnt vmcnt(11)
    v_mfma_f32_16x16x32_bf16 v[240:243], a[0:3], v[132:135], 0
    buffer_load_dwordx4 a[244:247], v3, s[56:59], s93 offen offset:1024 sc1
    v_mfma_f32_16x16x32_bf16 v[244:247], a[4:7], v[132:135], 0
    v_mfma_f32_16x16x32_bf16 v[248:251], a[8:11], v[132:135], 0
    v_mfma_f32_16x16x32_bf16 v[252:255], a[12:15], v[132:135], 0
    s_waitcnt vmcnt(11)
    v_mfma_f32_16x16x32_bf16 v[224:227], a[16:19], v[136:139], v[224:227]
    buffer_load_dwordx4 a[248:251], v3, s[56:59], s93 offen offset:2048 sc1
    v_mfma_f32_16x16x32_bf16 v[228:231], a[20:23], v[136:139], v[228:231]
    ds_write_b128 v184, v[192:195] offset:0
    v_mfma_f32_16x16x32_bf16 v[232:235], a[24:27], v[136:139], v[232:235]
    v_mfma_f32_16x16x32_bf16 v[236:239], a[28:31], v[136:139], v[236:239]
    ds_write_b128 v185, v[196:199] offset:0
    s_waitcnt vmcnt(11)
    v_mfma_f32_16x16x32_bf16 v[240:243], a[16:19], v[140:143], v[240:243]
    buffer_load_dwordx4 a[252:255], v3, s[56:59], s93 offen offset:3072 sc1
    v_mfma_f32_16x16x32_bf16 v[244:247], a[20:23], v[140:143], v[244:247]
    ds_write_b128 v184, v[200:203] offset:128
    v_mfma_f32_16x16x32_bf16 v[248:251], a[24:27], v[140:143], v[248:251]
    v_mfma_f32_16x16x32_bf16 v[252:255], a[28:31], v[140:143], v[252:255]
    ds_write_b128 v185, v[204:207] offset:128
    s_waitcnt vmcnt(11)
    v_mfma_f32_16x16x32_bf16 v[224:227], a[32:35], v[144:147], v[224:227]
    buffer_load_dwordx4 v[16:19], v3, s[56:59], s94 offen offset:0 sc1
    v_mfma_f32_16x16x32_bf16 v[228:231], a[36:39], v[144:147], v[228:231]
    ds_write_b128 v184, v[208:211] offset:4096
    v_mfma_f32_16x16x32_bf16 v[232:235], a[40:43], v[144:147], v[232:235]
    v_mfma_f32_16x16x32_bf16 v[236:239], a[44:47], v[144:147], v[236:239]
    ds_write_b128 v185, v[212:215] offset:4096
    s_waitcnt vmcnt(11)
    v_mfma_f32_16x16x32_bf16 v[240:243], a[32:35], v[148:151], v[240:243]
    buffer_load_dwordx4 v[20:23], v3, s[56:59], s94 offen offset:1024 sc1
    v_mfma_f32_16x16x32_bf16 v[244:247], a[36:39], v[148:151], v[244:247]
    ds_write_b128 v184, v[216:219] offset:4224
    v_mfma_f32_16x16x32_bf16 v[248:251], a[40:43], v[148:151], v[248:251]
    v_mfma_f32_16x16x32_bf16 v[252:255], a[44:47], v[148:151], v[252:255]
    ds_write_b128 v185, v[220:223] offset:4224
    s_waitcnt vmcnt(11)
    v_mfma_f32_16x16x32_bf16 v[224:227], a[48:51], v[152:155], v[224:227]
    buffer_load_dwordx4 v[24:27], v3, s[56:59], s94 offen offset:2048 sc1
    v_mfma_f32_16x16x32_bf16 v[228:231], a[52:55], v[152:155], v[228:231]
    s_waitcnt lgkmcnt(0)
    s_barrier
    v_mfma_f32_16x16x32_bf16 v[232:235], a[56:59], v[152:155], v[232:235]
    v_mfma_f32_16x16x32_bf16 v[236:239], a[60:63], v[152:155], v[236:239]
    ds_read_b128 v[160:163], v188 offset:0
    s_waitcnt vmcnt(11)
    v_mfma_f32_16x16x32_bf16 v[240:243], a[48:51], v[156:159], v[240:243]
    buffer_load_dwordx4 v[28:31], v3, s[56:59], s94 offen offset:3072 sc1
    v_mfma_f32_16x16x32_bf16 v[244:247], a[52:55], v[156:159], v[244:247]
    ds_read_b128 v[164:167], v189 offset:0
    v_mfma_f32_16x16x32_bf16 v[248:251], a[56:59], v[156:159], v[248:251]
    v_mfma_f32_16x16x32_bf16 v[252:255], a[60:63], v[156:159], v[252:255]
    ds_read_b128 v[168:171], v188 offset:8192
    s_waitcnt vmcnt(11)
    v_mfma_f32_16x16x32_bf16 v[224:227], a[64:67], a[224:227], v[224:227]
    buffer_load_dwordx4 v[32:35], v3, s[56:59], s95 offen offset:0 sc1
    v_mfma_f32_16x16x32_bf16 v[228:231], a[68:71], a[224:227], v[228:231]
    ds_read_b128 v[172:175], v189 offset:8192
    v_mfma_f32_16x16x32_bf16 v[232:235], a[72:75], a[224:227], v[232:235]
    v_mfma_f32_16x16x32_bf16 v[236:239], a[76:79], a[224:227], v[236:239]
    ds_read_b128 v[176:179], v188 offset:16384
    s_waitcnt vmcnt(11)
    v_mfma_f32_16x16x32_bf16 v[240:243], a[64:67], a[228:231], v[240:243]
    buffer_load_dwordx4 v[36:39], v3, s[56:59], s95 offen offset:1024 sc1
    v_mfma_f32_16x16x32_bf16 v[244:247], a[68:71], a[228:231], v[244:247]
    ds_read_b128 v[180:183], v189 offset:16384
    v_mfma_f32_16x16x32_bf16 v[248:251], a[72:75], a[228:231], v[248:251]
    v_mfma_f32_16x16x32_bf16 v[252:255], a[76:79], a[228:231], v[252:255]
    ds_read_b128 v[192:195], v188 offset:24576
    s_waitcnt vmcnt(11)
    v_mfma_f32_16x16x32_bf16 v[224:227], a[80:83], a[232:235], v[224:227]
    buffer_load_dwordx4 v[40:43], v3, s[56:59], s95 offen offset:2048 sc1
    v_mfma_f32_16x16x32_bf16 v[228:231], a[84:87], a[232:235], v[228:231]
    ds_read_b128 v[196:199], v189 offset:24576
    v_mfma_f32_16x16x32_bf16 v[232:235], a[88:91], a[232:235], v[232:235]
    v_mfma_f32_16x16x32_bf16 v[236:239], a[92:95], a[232:235], v[236:239]
    s_waitcnt lgkmcnt(4)
    s_waitcnt vmcnt(11)
    v_mfma_f32_16x16x32_bf16 v[240:243], a[80:83], a[236:239], v[240:243]
    buffer_load_dwordx4 v[44:47], v3, s[56:59], s95 offen offset:3072 sc1
    v_add_f32 v160, v160, v168
    v_mfma_f32_16x16x32_bf16 v[244:247], a[84:87], a[236:239], v[244:247]
    v_add_f32 v161, v161, v169
    v_mfma_f32_16x16x32_bf16 v[248:251], a[88:91], a[236:239], v[248:251]
    v_add_f32 v162, v162, v170
    v_mfma_f32_16x16x32_bf16 v[252:255], a[92:95], a[236:239], v[252:255]
    v_add_f32 v163, v163, v171
    s_waitcnt vmcnt(11)
    v_mfma_f32_16x16x32_bf16 v[224:227], a[96:99], a[240:243], v[224:227]
    buffer_load_dwordx4 v[48:51], v3, s[56:59], s4 offen offset:0 sc1
    v_add_f32 v164, v164, v172
    v_mfma_f32_16x16x32_bf16 v[228:231], a[100:103], a[240:243], v[228:231]
    v_add_f32 v165, v165, v173
    v_mfma_f32_16x16x32_bf16 v[232:235], a[104:107], a[240:243], v[232:235]
    v_add_f32 v166, v166, v174
    v_mfma_f32_16x16x32_bf16 v[236:239], a[108:111], a[240:243], v[236:239]
    v_add_f32 v167, v167, v175
    s_waitcnt vmcnt(11)
    v_mfma_f32_16x16x32_bf16 v[240:243], a[96:99], a[244:247], v[240:243]
    buffer_load_dwordx4 v[52:55], v3, s[56:59], s4 offen offset:1024 sc1
    v_mfma_f32_16x16x32_bf16 v[244:247], a[100:103], a[244:247], v[244:247]
    s_waitcnt lgkmcnt(0)
    v_mfma_f32_16x16x32_bf16 v[248:251], a[104:107], a[244:247], v[248:251]
    v_add_f32 v176, v176, v192
    v_mfma_f32_16x16x32_bf16 v[252:255], a[108:111], a[244:247], v[252:255]
    v_add_f32 v177, v177, v193
    s_waitcnt vmcnt(11)
    v_mfma_f32_16x16x32_bf16 v[224:227], a[112:115], a[248:251], v[224:227]
    buffer_load_dwordx4 v[56:59], v3, s[56:59], s4 offen offset:2048 sc1
    v_add_f32 v178, v178, v194
    v_mfma_f32_16x16x32_bf16 v[228:231], a[116:119], a[248:251], v[228:231]
    v_add_f32 v179, v179, v195
    v_mfma_f32_16x16x32_bf16 v[232:235], a[120:123], a[248:251], v[232:235]
    v_add_f32 v180, v180, v196
    v_mfma_f32_16x16x32_bf16 v[236:239], a[124:127], a[248:251], v[236:239]
    v_add_f32 v181, v181, v197
    s_waitcnt vmcnt(11)
    v_mfma_f32_16x16x32_bf16 v[240:243], a[112:115], a[252:255], v[240:243]
    buffer_load_dwordx4 v[60:63], v3, s[56:59], s4 offen offset:3072 sc1
    v_add_f32 v182, v182, v198
    v_mfma_f32_16x16x32_bf16 v[244:247], a[116:119], a[252:255], v[244:247]
    v_add_f32 v183, v183, v199
    v_mfma_f32_16x16x32_bf16 v[248:251], a[120:123], a[252:255], v[248:251]
    v_add_f32 v160, v160, v176
    v_mfma_f32_16x16x32_bf16 v[252:255], a[124:127], a[252:255], v[252:255]
    v_add_f32 v161, v161, v177
    s_waitcnt vmcnt(11)
    v_mfma_f32_16x16x32_bf16 v[224:227], a[128:131], v[16:19], v[224:227]
    s_cmp_eq_u32 s2, 255
    s_cselect_b32 s21, 0, 268435456
    s_lshl_b32 s22, s16, 15
    v_lshl_add_u32 v14, v1, 9, s22
    buffer_load_dwordx2 v[4:5], v14, s[60:63], s21 offen sc1
    v_add_f32 v162, v162, v178
    v_mfma_f32_16x16x32_bf16 v[228:231], a[132:135], v[16:19], v[228:231]
    v_add_f32 v163, v163, v179
    v_mfma_f32_16x16x32_bf16 v[232:235], a[136:139], v[16:19], v[232:235]
    v_add_f32 v164, v164, v180
    v_mfma_f32_16x16x32_bf16 v[236:239], a[140:143], v[16:19], v[236:239]
    v_add_f32 v165, v165, v181
    s_waitcnt vmcnt(11)
    v_mfma_f32_16x16x32_bf16 v[240:243], a[128:131], v[20:23], v[240:243]
    v_add_f32 v166, v166, v182
    v_mfma_f32_16x16x32_bf16 v[244:247], a[132:135], v[20:23], v[244:247]
    v_add_f32 v167, v167, v183
    v_mfma_f32_16x16x32_bf16 v[248:251], a[136:139], v[20:23], v[248:251]
    v_cvt_pk_bf16_f32 v160, v160, v161
    v_mfma_f32_16x16x32_bf16 v[252:255], a[140:143], v[20:23], v[252:255]
    v_cvt_pk_bf16_f32 v161, v162, v163
    s_waitcnt vmcnt(10)
    v_mfma_f32_16x16x32_bf16 v[224:227], a[144:147], v[24:27], v[224:227]
    v_cvt_pk_bf16_f32 v162, v164, v165
    v_mfma_f32_16x16x32_bf16 v[228:231], a[148:151], v[24:27], v[228:231]
    v_cvt_pk_bf16_f32 v163, v166, v167
    v_mfma_f32_16x16x32_bf16 v[232:235], a[152:155], v[24:27], v[232:235]
    v_mfma_f32_16x16x32_bf16 v[236:239], a[156:159], v[24:27], v[236:239]
    buffer_store_dwordx4 v[160:163], v190, s[52:55], s69 offen sc1
    s_waitcnt vmcnt(10)
    v_mfma_f32_16x16x32_bf16 v[240:243], a[144:147], v[28:31], v[240:243]
    v_mfma_f32_16x16x32_bf16 v[244:247], a[148:151], v[28:31], v[244:247]
    v_mfma_f32_16x16x32_bf16 v[248:251], a[152:155], v[28:31], v[248:251]
    v_mfma_f32_16x16x32_bf16 v[252:255], a[156:159], v[28:31], v[252:255]
    s_waitcnt vmcnt(9)
    v_mfma_f32_16x16x32_bf16 v[224:227], a[160:163], v[32:35], v[224:227]
    v_mfma_f32_16x16x32_bf16 v[228:231], a[164:167], v[32:35], v[228:231]
    v_mfma_f32_16x16x32_bf16 v[232:235], a[168:171], v[32:35], v[232:235]
    v_mfma_f32_16x16x32_bf16 v[236:239], a[172:175], v[32:35], v[236:239]
    s_waitcnt vmcnt(8)
    v_mfma_f32_16x16x32_bf16 v[240:243], a[160:163], v[36:39], v[240:243]
    v_mfma_f32_16x16x32_bf16 v[244:247], a[164:167], v[36:39], v[244:247]
    v_mfma_f32_16x16x32_bf16 v[248:251], a[168:171], v[36:39], v[248:251]
    v_mfma_f32_16x16x32_bf16 v[252:255], a[172:175], v[36:39], v[252:255]
    s_waitcnt vmcnt(7)
    v_mfma_f32_16x16x32_bf16 v[224:227], a[176:179], v[40:43], v[224:227]
    v_mfma_f32_16x16x32_bf16 v[228:231], a[180:183], v[40:43], v[228:231]
    v_mfma_f32_16x16x32_bf16 v[232:235], a[184:187], v[40:43], v[232:235]
    v_mfma_f32_16x16x32_bf16 v[236:239], a[188:191], v[40:43], v[236:239]
    s_waitcnt vmcnt(6)
    v_mfma_f32_16x16x32_bf16 v[240:243], a[176:179], v[44:47], v[240:243]
    v_mfma_f32_16x16x32_bf16 v[244:247], a[180:183], v[44:47], v[244:247]
    v_mfma_f32_16x16x32_bf16 v[248:251], a[184:187], v[44:47], v[248:251]
    v_mfma_f32_16x16x32_bf16 v[252:255], a[188:191], v[44:47], v[252:255]
    s_waitcnt vmcnt(5)
    v_mfma_f32_16x16x32_bf16 v[224:227], a[192:195], v[48:51], v[224:227]
    v_mfma_f32_16x16x32_bf16 v[228:231], a[196:199], v[48:51], v[228:231]
    v_mfma_f32_16x16x32_bf16 v[232:235], a[200:203], v[48:51], v[232:235]
    v_mfma_f32_16x16x32_bf16 v[236:239], a[204:207], v[48:51], v[236:239]
    s_waitcnt vmcnt(4)
    v_mfma_f32_16x16x32_bf16 v[240:243], a[192:195], v[52:55], v[240:243]
    v_mfma_f32_16x16x32_bf16 v[244:247], a[196:199], v[52:55], v[244:247]
    v_mfma_f32_16x16x32_bf16 v[248:251], a[200:203], v[52:55], v[248:251]
    v_mfma_f32_16x16x32_bf16 v[252:255], a[204:207], v[52:55], v[252:255]
    s_waitcnt vmcnt(3)
    v_mfma_f32_16x16x32_bf16 v[224:227], a[208:211], v[56:59], v[224:227]
    v_mfma_f32_16x16x32_bf16 v[228:231], a[212:215], v[56:59], v[228:231]
    v_mfma_f32_16x16x32_bf16 v[232:235], a[216:219], v[56:59], v[232:235]
    v_mfma_f32_16x16x32_bf16 v[236:239], a[220:223], v[56:59], v[236:239]
    s_waitcnt vmcnt(2)
    v_mfma_f32_16x16x32_bf16 v[240:243], a[208:211], v[60:63], v[240:243]
    v_mfma_f32_16x16x32_bf16 v[244:247], a[212:215], v[60:63], v[244:247]
    v_mfma_f32_16x16x32_bf16 v[248:251], a[216:219], v[60:63], v[248:251]
    v_mfma_f32_16x16x32_bf16 v[252:255], a[220:223], v[60:63], v[252:255]
    s_cmp_eq_u32 s2, 255
    s_cbranch_scc1 L_chk
L_chkd:
    s_nop 1
    ds_write_b128 v184, v[224:227] offset:32768
    ds_write_b128 v185, v[228:231] offset:32768
    ds_write_b128 v184, v[232:235] offset:32896
    ds_write_b128 v185, v[236:239] offset:32896
    ds_write_b128 v184, v[240:243] offset:36864
    ds_write_b128 v185, v[244:247] offset:36864
    ds_write_b128 v184, v[248:251] offset:36992
    ds_write_b128 v185, v[252:255] offset:36992
    s_waitcnt lgkmcnt(0)
    s_barrier
    ds_read_b128 v[160:163], v188 offset:32768
    ds_read_b128 v[164:167], v189 offset:32768
    ds_read_b128 v[168:171], v188 offset:40960
    ds_read_b128 v[172:175], v189 offset:40960
    ds_read_b128 v[176:179], v188 offset:49152
    ds_read_b128 v[180:183], v189 offset:49152
    ds_read_b128 v[224:227], v188 offset:57344
    ds_read_b128 v[228:231], v189 offset:57344
    s_cmp_eq_u32 s2, 255
    s_cselect_b32 s21, s16, 1
    s_cmp_eq_u32 s21, 0
    s_cbranch_scc1 L_bump
L_bumpd:
    s_waitcnt lgkmcnt(4)
    v_pk_add_f32 v[160:161], v[160:161], v[168:169]
    v_pk_add_f32 v[162:163], v[162:163], v[170:171]
    v_pk_add_f32 v[164:165], v[164:165], v[172:173]
    v_pk_add_f32 v[166:167], v[166:167], v[174:175]
    s_waitcnt lgkmcnt(0)
    v_pk_add_f32 v[176:177], v[176:177], v[224:225]
    v_pk_add_f32 v[178:179], v[178:179], v[226:227]
    v_pk_add_f32 v[180:181], v[180:181], v[228:229]
    v_pk_add_f32 v[182:183], v[182:183], v[230:231]
    v_pk_add_f32 v[160:161], v[160:161], v[176:177]
    v_pk_add_f32 v[162:163], v[162:163], v[178:179]
    v_pk_add_f32 v[164:165], v[164:165], v[180:181]
    v_pk_add_f32 v[166:167], v[166:167], v[182:183]
    v_cvt_pk_bf16_f32 v160, v160, v161
    v_cvt_pk_bf16_f32 v161, v162, v163
    v_cvt_pk_bf16_f32 v162, v164, v165
    v_cvt_pk_bf16_f32 v163, v166, v167
    buffer_store_dwordx4 v[160:163], v190, s[52:55], s38 offen sc1
    s_endpgm
L_slow:
    s_mov_b32 s23, 0
L_poll:
    s_add_u32 s23, s23, 1
    s_cmp_gt_u32 s23, 0x400000
    s_cbranch_scc1 L_go
    buffer_load_dwordx2 v[160:161], v14, s[60:63], 0 offen sc1
    s_waitcnt vmcnt(0)
    v_cmp_ne_u64 vcc, s[24:25], v[160:161]
    s_cbranch_vccnz L_poll
    s_branch L_go
L_chk:
    s_mov_b32 s23, 0
L_chk2:
    s_waitcnt vmcnt(0)
    v_cmp_ne_u64 vcc, s[24:25], v[4:5]
    s_cbranch_vccz L_chkd
    s_add_u32 s23, s23, 1
    s_cmp_gt_u32 s23, 0x400000
    s_cbranch_scc1 L_chkd
    buffer_load_dwordx2 v[4:5], v14, s[60:63], 0 offen sc1
    s_branch L_chk2
L_bump:
    v_mov_b32 v14, 262144
    v_mov_b32 v4, s24
    v_mov_b32 v5, s25
    s_mov_b64 exec, 1
    buffer_store_dwordx2 v[4:5], v14, s[60:63], 0 offen sc1
    s_mov_b64 exec, -1
    s_branch L_bumpd
L_idle:
    s_mov_b32 s46, 1835008
    s_mov_b32 s47, 0x20000
    s_lshl_b32 s28, s16, 13
    s_lshl_b32 s39, s17, 2
    s_add_u32 s39, s39, s18
    s_sub_u32 s39, s39, 28
    s_lshr_b32 s19, s39, 1
    s_and_b32 s20, s39, 1
    s_add_u32 s20, s20, 14
    s_lshr_b32 s22, s17, 1
    s_lshl_b32 s22, s22, 19
    s_and_b32 s23, s18, 3
    s_lshl_b32 s23, s23, 17
    s_add_u32 s22, s22, s23
    s_and_b32 s23, s17, 1
    s_lshl_b32 s23, s23, 16
    s_add_u32 s22, s22, s23
    v_lshl_add_u32 v168, v1, 10, s22
    v_min_u32 v170, 55, v1
    v_mul_u32_u24 v172, 9363, v170
    v_lshrrev_b32 v172, 16, v172
    v_mul_u32_u24 v171, 7, v172
    v_sub_u32 v170, v170, v171
    v_lshlrev_b32 v170, 8, v170
    v_lshrrev_b32 v171, 2, v172
    v_and_b32 v169, 3, v172
    v_lshl_add_u32 v169, v171, 6, v169
    s_lshr_b32 s22, s17, 1
    s_lshl_b32 s22, s22, 2
    s_and_b32 s23, s18, 3
    s_add_u32 s22, s22, s23
    s_lshl_b32 s22, s22, 2
    v_add_u32 v169, s22, v169
    v_mul_u32_u24 v169, 3584, v169
    v_add_u32 v169, v169, v170
    s_and_b32 s22, s17, 1
    s_mul_i32 s22, s22, 1792
    v_add_u32 v169, s22, v169
    v_mov_b32 v171, v169
    s_cmp_lg_u32 s16, 0
    s_cbranch_scc1 L_pfo0
    buffer_load_dword v15, v168, s[40:43], 0 offen offset:128
    buffer_load_dword v15, v168, s[40:43], 0 offen offset:256
    buffer_load_dword v15, v168, s[40:43], 0 offen offset:384
    s_mov_b32 s22, 0
    buffer_load_dword v15, v171, s[44:47], s22 offen offset:128
    s_branch L_pfox
L_pfo0:
    s_cmp_lg_u32 s16, 1
    s_cbranch_scc1 L_pfo1
    buffer_load_dword v15, v168, s[40:43], 0 offen offset:640
    buffer_load_dword v15, v168, s[40:43], 0 offen offset:768
    buffer_load_dword v15, v168, s[40:43], 0 offen offset:896
    s_mov_b32 s22, 458752
    buffer_load_dword v15, v171, s[44:47], s22 offen offset:128
    s_branch L_pfox
L_pfo1:
    s_cmp_lg_u32 s16, 2
    s_cbranch_scc1 L_pfo2
    s_mov_b32 s22, 229376
    buffer_load_dword v15, v169, s[44:47], s22 offen
    s_mov_b32 s22, 688128
    buffer_load_dword v15, v169, s[44:47], s22 offen
    s_mov_b32 s22, 917504
    buffer_load_dword v15, v171, s[44:47], s22 offen offset:128
    s_branch L_pfox
L_pfo2:
    s_mov_b32 s22, 1146880
    buffer_load_dword v15, v169, s[44:47], s22 offen
    s_mov_b32 s22, 1605632
    buffer_load_dword v15, v169, s[44:47], s22 offen
    s_mov_b32 s22, 1376256
    buffer_load_dword v15, v171, s[44:47], s22 offen offset:128
L_pfox:
    s_load_dwordx2 s[24:25], s[14:15], 262144
    s_mov_b32 s48, s8
    s_mov_b32 s49, s9
    s_mov_b32 s50, 1835008
    s_mov_b32 s51, 0x20000
    s_mov_b32 s52, s10
    s_mov_b32 s53, s11
    s_mov_b32 s54, 2097152
    s_mov_b32 s55, 0x20000
    s_mov_b32 s60, s14
    s_mov_b32 s61, s15
    s_mov_b32 s62, 262272
    s_mov_b32 s63, 0x20000
    s_add_u32 s56, s14, 1048576
    s_addc_u32 s57, s15, 0
    s_mov_b32 s58, 7340032
    s_mov_b32 s59, 0x20000
    s_mul_i32 s21, s18, 37
    s_lshr_b32 s21, s21, 8
    s_mul_i32 s22, s21, 7
    s_sub_u32 s22, s18, s22
    s_cmp_ge_u32 s22, 3
    s_addc_u32 s32, s22, 0
    s_cmp_ge_u32 s18, 28
    s_cselect_b32 s21, s22, s21
    s_cselect_b32 s32, 3, s32
    s_lshl_b32 s22, s17, 2
    s_add_u32 s36, s21, s22
    s_mov_b32 s29, 0
    s_movk_i32 s90, 0
    s_movk_i32 s91, 4096
    s_movk_i32 s92, 8192
    s_movk_i32 s93, 12288
    s_movk_i32 s94, 16384
    s_movk_i32 s95, 20480
    s_movk_i32 s4, 24576
    s_mul_i32 s21, s16, 458752
    s_lshl_b32 s22, s32, 7
    s_add_u32 s21, s21, s22
    v_lshrrev_b32 v164, 3, v1
    v_lshl_add_u32 v164, v164, 10, s21
    v_lshrrev_b32 v165, 4, v1
    v_lshlrev_b32 v165, 1, v165
    v_and_b32 v166, 7, v1
    v_xor_b32 v166, v166, v165
    v_lshl_add_u32 v4, v166, 4, v164
    v_add_u32 v5, 7168, v4
    v_add_u32 v6, 14336, v4
    v_add_u32 v7, 21504, v4
    v_lshrrev_b32 v164, 5, v1
    v_lshlrev_b32 v164, 4, v164
    v_bfe_u32 v165, v1, 2, 3
    v_add_u32 v164, v164, v165
    v_lshl_add_u32 v164, v164, 7, s28
    v_lshrrev_b32 v165, 1, v165
    v_lshl_add_u32 v164, v165, 5, v164
    v_and_b32 v166, 3, v1
    v_lshl_add_u32 v8, v166, 3, v164
    v_xor_b32 v9, 32, v8
    v_xor_b32 v10, 64, v8
    v_xor_b32 v11, 96, v8
    v_add_u32 v12, 65536, v8
    v_add_u32 v13, 65536, v9
    v_add_u32 v0, 65536, v10
    v_add_u32 v191, 65536, v11
    v_add_u32 v180, 131072, v8
    v_add_u32 v181, 131072, v9
    v_add_u32 v182, 131072, v10
    v_add_u32 v183, 131072, v11
    s_lshr_b32 s21, s36, 1
    s_lshl_b32 s34, s21, 4
    s_mul_i32 s22, s16, 7
    s_lshr_b32 s22, s22, 1
    s_add_u32 s22, s22, s34
    s_lshl_b32 s22, s22, 2
    s_and_b32 s23, s36, 1
    s_lshl_b32 s23, s23, 1
    s_add_u32 s22, s22, s23
    s_lshl_b32 s22, s22, 7
    v_bfe_u32 v164, v1, 1, 2
    v_and_b32 v165, 1, v1
    v_lshl_add_u32 v164, v164, 2, v165
    v_lshl_add_u32 v14, v164, 7, s22
    s_lshl_b32 s35, s19, 4
    s_add_u32 s35, s35, s20
    s_lshl_b32 s35, s35, 2
    s_add_u32 s35, s35, s16
    s_lshl_b32 s35, s35, 7
    s_lshl_b32 s21, s19, 2
    s_add_u32 s21, s21, s16
    s_mul_i32 s21, s21, 112
    s_lshl_b32 s22, s20, 3
    s_add_u32 s21, s21, s22
    s_lshl_b32 s21, s21, 10
    v_and_b32 v164, 15, v1
    v_lshl_add_u32 v164, v164, 4, s21
    v_bfe_u32 v165, v1, 4, 1
    v_lshl_add_u32 v164, v165, 10, v164
    v_lshrrev_b32 v165, 5, v1
    v_lshl_add_u32 v2, v165, 8, v164
    v_and_b32 v164, 15, v1
    v_lshl_add_u32 v164, v164, 8, s28
    v_lshrrev_b32 v165, 4, v1
    v_and_b32 v166, 7, v1
    v_xor_b32 v165, v165, v166
    v_lshl_add_u32 v184, v165, 4, v164
    v_xor_b32 v185, 64, v184
    s_lshl_b32 s21, s16, 11
    v_lshrrev_b32 v164, 3, v1
    v_lshlrev_b32 v165, 1, v166
    v_xor_b32 v165, v165, v164
    v_lshl_add_u32 v188, v164, 8, s21
    v_lshl_add_u32 v188, v165, 4, v188
    v_xor_b32 v189, 16, v188
    s_lshl_b32 s21, s36, 16
    s_lshl_b32 s22, s16, 13
    s_add_u32 s21, s21, s22
    s_lshl_b32 s22, s32, 7
    s_add_u32 s21, s21, s22
    v_lshl_add_u32 v164, v164, 10, s21
    v_lshl_add_u32 v190, v166, 4, v164
    s_mul_i32 s21, s36, 224
    s_mul_i32 s22, s16, 28
    s_add_u32 s21, s21, s22
    s_lshl_b32 s37, s21, 10
    s_mov_b32 s68, 114688
    s_mov_b32 s69, 0
    s_mov_b32 s38, 32768
    s_lshr_b32 s22, s39, 3
    s_mul_i32 s22, s22, 458752
    s_and_b32 s23, s39, 7
    s_lshl_b32 s23, s23, 13
    s_add_u32 s22, s22, s23
    v_lshl_add_u32 v170, v1, 7, s22
    s_lshl_b32 s22, s16, 16
    buffer_load_dword v15, v170, s[48:51], s22 offen
    s_add_u32 s22, s22, 262144
    s_cmp_eq_u32 s16, 3
    s_cselect_b32 s22, 268435456, s22
    buffer_load_dword v15, v170, s[48:51], s22 offen
    s_waitcnt lgkmcnt(0)
    s_barrier
    s_add_u32 s24, s24, 454962503
    s_addc_u32 s25, s25, 982451653
    v_mov_b32 v164, s35
    v_mov_b32 v166, s24
    v_mov_b32 v167, s25
    s_mov_b64 exec, 1
    buffer_store_dwordx2 v[166:167], v164, s[60:63], 0 offen sc1
    s_mov_b64 exec, -1
    s_mul_i32 s21, s16, 458752
    s_and_b32 s22, s18, 3
    s_lshl_b32 s22, s22, 7
    s_add_u32 s21, s21, s22
    v_lshl_add_u32 v168, v1, 10, s21
    s_and_b32 s21, s18, 3
    s_mul_i32 s21, s21, 2
    s_lshl_b32 s29, s21, 16
    s_lshl_b32 s90, s21, 12
    s_add_u32 s91, s90, 4096
    s_cmp_eq_u32 s91, 28672
    s_cselect_b32 s91, 0, s91
    s_add_u32 s92, s91, 4096
    s_cmp_eq_u32 s92, 28672
    s_cselect_b32 s92, 0, s92
    s_add_u32 s93, s92, 4096
    s_cmp_eq_u32 s93, 28672
    s_cselect_b32 s93, 0, s93
    s_add_u32 s94, s93, 4096
    s_cmp_eq_u32 s94, 28672
    s_cselect_b32 s94, 0, s94
    s_add_u32 s95, s94, 4096
    s_cmp_eq_u32 s95, 28672
    s_cselect_b32 s95, 0, s95
    s_add_u32 s4, s95, 4096
    s_cmp_eq_u32 s4, 28672
    s_cselect_b32 s4, 0, s4
    s_add_u32 m0, s28, 0
    s_nop 0
    buffer_load_dwordx4 v4, s[48:51], s29 offen offset:0 lds
    buffer_load_dwordx4 v5, s[48:51], s29 offen offset:1024 lds
    buffer_load_dwordx4 v6, s[48:51], s29 offen offset:2048 lds
    buffer_load_dwordx4 v7, s[48:51], s29 offen offset:3072 lds
    s_add_u32 s29, s29, 32768
    s_add_u32 m0, s28, 4096
    s_nop 0
    buffer_load_dwordx4 v4, s[48:51], s29 offen offset:0 lds
    buffer_load_dwordx4 v5, s[48:51], s29 offen offset:1024 lds
    buffer_load_dwordx4 v6, s[48:51], s29 offen offset:2048 lds
    buffer_load_dwordx4 v7, s[48:51], s29 offen offset:3072 lds
    s_add_u32 s29, s29, 32768
    s_cmp_eq_u32 s29, 458752
    s_cselect_b32 s29, 0, s29
    s_add_u32 m0, s28, 32768
    s_nop 0
    buffer_load_dwordx4 v4, s[48:51], s29 offen offset:0 lds
    buffer_load_dwordx4 v5, s[48:51], s29 offen offset:1024 lds
    buffer_load_dwordx4 v6, s[48:51], s29 offen offset:2048 lds
    buffer_load_dwordx4 v7, s[48:51], s29 offen offset:3072 lds
    s_add_u32 s29, s29, 32768
    s_add_u32 m0, s28, 36864
    s_nop 0
    buffer_load_dwordx4 v4, s[48:51], s29 offen offset:0 lds
    buffer_load_dwordx4 v5, s[48:51], s29 offen offset:1024 lds
    buffer_load_dwordx4 v6, s[48:51], s29 offen offset:2048 lds
    buffer_load_dwordx4 v7, s[48:51], s29 offen offset:3072 lds
    s_add_u32 s29, s29, 32768
    s_cmp_eq_u32 s29, 458752
    s_cselect_b32 s29, 0, s29
    s_add_u32 m0, s28, 65536
    s_nop 0
    buffer_load_dwordx4 v4, s[48:51], s29 offen offset:0 lds
    buffer_load_dwordx4 v5, s[48:51], s29 offen offset:1024 lds
    buffer_load_dwordx4 v6, s[48:51], s29 offen offset:2048 lds
    buffer_load_dwordx4 v7, s[48:51], s29 offen offset:3072 lds
    s_add_u32 s29, s29, 32768
    s_add_u32 m0, s28, 69632
    s_nop 0
    buffer_load_dwordx4 v4, s[48:51], s29 offen offset:0 lds
    buffer_load_dwordx4 v5, s[48:51], s29 offen offset:1024 lds
    buffer_load_dwordx4 v6, s[48:51], s29 offen offset:2048 lds
    buffer_load_dwordx4 v7, s[48:51], s29 offen offset:3072 lds
    s_add_u32 s29, s29, 32768
    s_cmp_eq_u32 s29, 458752
    s_cselect_b32 s29, 0, s29
    s_add_u32 m0, s28, 98304
    s_nop 0
    buffer_load_dwordx4 v4, s[48:51], s29 offen offset:0 lds
    buffer_load_dwordx4 v5, s[48:51], s29 offen offset:1024 lds
    buffer_load_dwordx4 v6, s[48:51], s29 offen offset:2048 lds
    buffer_load_dwordx4 v7, s[48:51], s29 offen offset:3072 lds
    s_add_u32 s29, s29, 32768
    s_add_u32 m0, s28, 102400
    s_nop 0
    buffer_load_dwordx4 v4, s[48:51], s29 offen offset:0 lds
    buffer_load_dwordx4 v5, s[48:51], s29 offen offset:1024 lds
    buffer_load_dwordx4 v6, s[48:51], s29 offen offset:2048 lds
    buffer_load_dwordx4 v7, s[48:51], s29 offen offset:3072 lds
    s_add_u32 s29, s29, 32768
    s_cmp_eq_u32 s29, 458752
    s_cselect_b32 s29, 0, s29
    s_add_u32 m0, s28, 131072
    s_nop 0
    buffer_load_dwordx4 v4, s[48:51], s29 offen offset:0 lds
    buffer_load_dwordx4 v5, s[48:51], s29 offen offset:1024 lds
    buffer_load_dwordx4 v6, s[48:51], s29 offen offset:2048 lds
    buffer_load_dwordx4 v7, s[48:51], s29 offen offset:3072 lds
    s_add_u32 s29, s29, 32768
    s_add_u32 m0, s28, 135168
    s_nop 0
    buffer_load_dwordx4 v4, s[48:51], s29 offen offset:0 lds
    buffer_load_dwordx4 v5, s[48:51], s29 offen offset:1024 lds
    buffer_load_dwordx4 v6, s[48:51], s29 offen offset:2048 lds
    buffer_load_dwordx4 v7, s[48:51], s29 offen offset:3072 lds
    s_add_u32 s29, s29, 32768
    s_cmp_eq_u32 s29, 458752
    s_cselect_b32 s29, 0, s29
    s_waitcnt vmcnt(32)
    ds_read_b64_tr_b16 a[0:1], v8 offset:0
    ds_read_b64_tr_b16 a[2:3], v8 offset:1024
    ds_read_b64_tr_b16 a[4:5], v9 offset:0
    ds_read_b64_tr_b16 a[6:7], v9 offset:1024
    ds_read_b64_tr_b16 a[8:9], v10 offset:0
    ds_read_b64_tr_b16 a[10:11], v10 offset:1024
    ds_read_b64_tr_b16 a[12:13], v11 offset:0
    ds_read_b64_tr_b16 a[14:15], v11 offset:1024
    ds_read_b64_tr_b16 a[16:17], v8 offset:4096
    ds_read_b64_tr_b16 a[18:19], v8 offset:5120
    ds_read_b64_tr_b16 a[20:21], v9 offset:4096
    ds_read_b64_tr_b16 a[22:23], v9 offset:5120
    ds_read_b64_tr_b16 a[24:25], v10 offset:4096
    ds_read_b64_tr_b16 a[26:27], v10 offset:5120
    ds_read_b64_tr_b16 a[28:29], v11 offset:4096
    ds_read_b64_tr_b16 a[30:31], v11 offset:5120
    s_waitcnt lgkmcnt(0)
    s_add_u32 m0, s28, 0
    s_nop 0
    buffer_load_dwordx4 v4, s[48:51], s29 offen offset:0 lds
    buffer_load_dwordx4 v5, s[48:51], s29 offen offset:1024 lds
    buffer_load_dwordx4 v6, s[48:51], s29 offen offset:2048 lds
    buffer_load_dwordx4 v7, s[48:51], s29 offen offset:3072 lds
    s_add_u32 s29, s29, 32768
    s_add_u32 m0, s28, 4096
    s_nop 0
    buffer_load_dwordx4 v4, s[48:51], s29 offen offset:0 lds
    buffer_load_dwordx4 v5, s[48:51], s29 offen offset:1024 lds
    buffer_load_dwordx4 v6, s[48:51], s29 offen offset:2048 lds
    buffer_load_dwordx4 v7, s[48:51], s29 offen offset:3072 lds
    s_add_u32 s29, s29, 32768
    s_cmp_eq_u32 s29, 458752
    s_cselect_b32 s29, 0, s29
    s_waitcnt vmcnt(32)
    ds_read_b64_tr_b16 a[32:33], v8 offset:32768
    ds_read_b64_tr_b16 a[34:35], v8 offset:33792
    ds_read_b64_tr_b16 a[36:37], v9 offset:32768
    ds_read_b64_tr_b16 a[38:39], v9 offset:33792
    ds_read_b64_tr_b16 a[40:41], v10 offset:32768
    ds_read_b64_tr_b16 a[42:43], v10 offset:33792
    ds_read_b64_tr_b16 a[44:45], v11 offset:32768
    ds_read_b64_tr_b16 a[46:47], v11 offset:33792
    ds_read_b64_tr_b16 a[48:49], v8 offset:36864
    ds_read_b64_tr_b16 a[50:51], v8 offset:37888
    ds_read_b64_tr_b16 a[52:53], v9 offset:36864
    ds_read_b64_tr_b16 a[54:55], v9 offset:37888
    ds_read_b64_tr_b16 a[56:57], v10 offset:36864
    ds_read_b64_tr_b16 a[58:59], v10 offset:37888
    ds_read_b64_tr_b16 a[60:61], v11 offset:36864
    ds_read_b64_tr_b16 a[62:63], v11 offset:37888
    s_waitcnt lgkmcnt(0)
    s_add_u32 m0, s28, 32768
    s_nop 0
    buffer_load_dwordx4 v4, s[48:51], s29 offen offset:0 lds
    buffer_load_dwordx4 v5, s[48:51], s29 offen offset:1024 lds
    buffer_load_dwordx4 v6, s[48:51], s29 offen offset:2048 lds
    buffer_load_dwordx4 v7, s[48:51], s29 offen offset:3072 lds
    s_add_u32 s29, s29, 32768
    s_add_u32 m0, s28, 36864
    s_nop 0
    buffer_load_dwordx4 v4, s[48:51], s29 offen offset:0 lds
    buffer_load_dwordx4 v5, s[48:51], s29 offen offset:1024 lds
    buffer_load_dwordx4 v6, s[48:51], s29 offen offset:2048 lds
    buffer_load_dwordx4 v7, s[48:51], s29 offen offset:3072 lds
    s_add_u32 s29, s29, 32768
    s_cmp_eq_u32 s29, 458752
    s_cselect_b32 s29, 0, s29
    s_waitcnt vmcnt(32)
    ds_read_b64_tr_b16 a[64:65], v12 offset:0
    ds_read_b64_tr_b16 a[66:67], v12 offset:1024
    ds_read_b64_tr_b16 a[68:69], v13 offset:0
    ds_read_b64_tr_b16 a[70:71], v13 offset:1024
    ds_read_b64_tr_b16 a[72:73], v0 offset:0
    ds_read_b64_tr_b16 a[74:75], v0 offset:1024
    ds_read_b64_tr_b16 a[76:77], v191 offset:0
    ds_read_b64_tr_b16 a[78:79], v191 offset:1024
    ds_read_b64_tr_b16 a[80:81], v12 offset:4096
    ds_read_b64_tr_b16 a[82:83], v12 offset:5120
    ds_read_b64_tr_b16 a[84:85], v13 offset:4096
    ds_read_b64_tr_b16 a[86:87], v13 offset:5120
    ds_read_b64_tr_b16 a[88:89], v0 offset:4096
    ds_read_b64_tr_b16 a[90:91], v0 offset:5120
    ds_read_b64_tr_b16 a[92:93], v191 offset:4096
    ds_read_b64_tr_b16 a[94:95], v191 offset:5120
    s_waitcnt vmcnt(24)
    ds_read_b64_tr_b16 a[96:97], v12 offset:32768
    ds_read_b64_tr_b16 a[98:99], v12 offset:33792
    ds_read_b64_tr_b16 a[100:101], v13 offset:32768
    ds_read_b64_tr_b16 a[102:103], v13 offset:33792
    ds_read_b64_tr_b16 a[104:105], v0 offset:32768
    ds_read_b64_tr_b16 a[106:107], v0 offset:33792
    ds_read_b64_tr_b16 a[108:109], v191 offset:32768
    ds_read_b64_tr_b16 a[110:111], v191 offset:33792
    ds_read_b64_tr_b16 a[112:113], v12 offset:36864
    ds_read_b64_tr_b16 a[114:115], v12 offset:37888
    ds_read_b64_tr_b16 a[116:117], v13 offset:36864
    ds_read_b64_tr_b16 a[118:119], v13 offset:37888
    ds_read_b64_tr_b16 a[120:121], v0 offset:36864
    ds_read_b64_tr_b16 a[122:123], v0 offset:37888
    ds_read_b64_tr_b16 a[124:125], v191 offset:36864
    ds_read_b64_tr_b16 a[126:127], v191 offset:37888
    s_waitcnt vmcnt(16)
    ds_read_b64_tr_b16 a[128:129], v180 offset:0
    ds_read_b64_tr_b16 a[130:131], v180 offset:1024
    ds_read_b64_tr_b16 a[132:133], v181 offset:0
    ds_read_b64_tr_b16 a[134:135], v181 offset:1024
    ds_read_b64_tr_b16 a[136:137], v182 offset:0
    ds_read_b64_tr_b16 a[138:139], v182 offset:1024
    ds_read_b64_tr_b16 a[140:141], v183 offset:0
    ds_read_b64_tr_b16 a[142:143], v183 offset:1024
    ds_read_b64_tr_b16 a[144:145], v180 offset:4096
    ds_read_b64_tr_b16 a[146:147], v180 offset:5120
    ds_read_b64_tr_b16 a[148:149], v181 offset:4096
    ds_read_b64_tr_b16 a[150:151], v181 offset:5120
    ds_read_b64_tr_b16 a[152:153], v182 offset:4096
    ds_read_b64_tr_b16 a[154:155], v182 offset:5120
    ds_read_b64_tr_b16 a[156:157], v183 offset:4096
    ds_read_b64_tr_b16 a[158:159], v183 offset:5120
    v_lshl_add_u32 v2, v1, 4, s37
    v_add_u32 v3, s68, v2
    s_waitcnt vmcnt(0)
    s_branch L_slow
L_end:
    s_endpgm
.section .rodata,"a"
.p2align 6
.amdhsa_kernel standalone__dense_activation_relu__prompt_kernel
  .amdhsa_next_free_vgpr 512
  .amdhsa_next_free_sgpr 102
  .amdhsa_accum_offset 256
  .amdhsa_group_segment_fixed_size 0
  .amdhsa_kernarg_size 48
  .amdhsa_float_denorm_mode_32 3
  .amdhsa_user_sgpr_count 2
  .amdhsa_user_sgpr_kernarg_segment_ptr 1
  .amdhsa_system_sgpr_workgroup_id_x 1
.end_amdhsa_kernel
```
